```python
import torch

def _softmax(x, axis=-1):
    return torch.softmax(x, dim=axis)
def _gelu(x):
    return torch.nn.functional.gelu(x, approximate="tanh")
def _silu(x):
    return torch.nn.functional.silu(x)
def _sigmoid(x):
    return torch.sigmoid(x)
def _layernorm(x, axis=-1, eps=1e-5):
    m = x.mean(dim=axis, keepdim=True)
    v = x.var(dim=axis, keepdim=True, unbiased=False)
    return (x - m) / torch.sqrt(v + eps)
def _scatter_add(tgt, idx, src, axis=0):
    return tgt.clone().index_add_(axis, idx, src)
def _segment_sum(src, seg, n):
    out = torch.zeros((n,) + src.shape[1:], dtype=src.dtype)
    return out.index_add_(0, seg, src)
def _pad(x, pw):
    flat = tuple(v for pair in reversed(pw) for v in pair)
    return torch.nn.functional.pad(x, flat)

kernel_name = 'gated_mix__spectral_fnet__dense_activation_squared_relu__prompt'

def setup_inputs():

    _w = (lambda a: (lambda t: t.to(torch.bfloat16) if t.is_floating_point() else t)(torch.as_tensor(a)))
    def _A_setup():
        B, S, D = 1, 2048, 1024
        ns = torch.arange(S)[:, None] * torch.arange(S)[None, :]
        nd = torch.arange(D)[:, None] * torch.arange(D)[None, :]
        Ws_re = torch.cos(-2.0 * torch.pi * ns / S).to(float)
        Ws_im = torch.sin(-2.0 * torch.pi * ns / S).to(float)
        Wd_re = torch.cos(-2.0 * torch.pi * nd / D).to(float)
        Wd_im = torch.sin(-2.0 * torch.pi * nd / D).to(float)
        return {
            "x": _w((lambda *s: torch.randn(*s, dtype=torch.bfloat16) * 0.05)(B, S, D)),
            "dft_seq_re": _w(Ws_re),
            "dft_seq_im": _w(Ws_im),
            "dft_hid_re": _w(Wd_re),
            "dft_hid_im": _w(Wd_im),
        }
    _A_in = _A_setup()

    def _B_setup():
        B, S, D, F = 1, 2048, 1024, 3584
        return {
            "x": _w((lambda *s: torch.randn(*s, dtype=torch.bfloat16) * 0.05)(B, S, D)),
            "w1": _w((lambda *s: torch.randn(*s, dtype=torch.bfloat16) * 0.4)(D, F)),
            "b1": _w((lambda *s: torch.randn(*s, dtype=torch.bfloat16) * 0.4)(F)),
            "w2": _w((lambda *s: torch.randn(*s, dtype=torch.bfloat16) * 0.4)(F, D)),
            "b2": _w((lambda *s: torch.randn(*s, dtype=torch.bfloat16) * 12.8)(D)),
        }
    _B_in = _B_setup()

    return {
        "A_x": _A_in["x"],
        "A_dft_seq_re": _A_in["dft_seq_re"],
        "A_dft_seq_im": _A_in["dft_seq_im"],
        "A_dft_hid_re": _A_in["dft_hid_re"],
        "A_dft_hid_im": _A_in["dft_hid_im"],
        "B_x": _B_in["x"],
        "B_w1": _B_in["w1"],
        "B_b1": _B_in["b1"],
        "B_w2": _B_in["w2"],
        "B_b2": _B_in["b2"],
        "gate_w": _w((lambda *s: torch.randn(*s, dtype=torch.bfloat16) * 0.05)(1024) * 16.0),
    }

def reference(A_x, A_dft_seq_re, A_dft_seq_im, A_dft_hid_re, A_dft_hid_im, B_x, B_w1, B_b1, B_w2, B_b2, gate_w):
    def _A_ref(x, dft_seq_re, dft_seq_im, dft_hid_re, dft_hid_im):
        a = torch.einsum("bsd,ed->bse", x, dft_hid_re)
        b = torch.einsum("bsd,ed->bse", x, dft_hid_im)
        y = torch.einsum("ts,bse->bte", dft_seq_re, a) - torch.einsum("ts,bse->bte", dft_seq_im, b)
        return y

    def _B_ref(x, w1, b1, w2, b2):
        h = torch.einsum("bsd,df->bsf", x, w1) + b1
        zero = torch.zeros_like(h)
        r = torch.where(h > zero, h, zero)
        h = r * r
        out = torch.einsum("bsf,fd->bsd", h, w2) + b2
        return out

    x = A_x
    g = _sigmoid((x * gate_w).sum(-1, keepdims=True))
    a = _A_ref(x, A_dft_seq_re, A_dft_seq_im, A_dft_hid_re, A_dft_hid_im)
    b = _B_ref(x, B_w1, B_b1, B_w2, B_b2)
    return g * a + (1 - g) * b
```

```asm
; @launch grid=(256,1,1) block=(512,1,1) lds=163840
.amdgcn_target "amdgcn-amd-amdhsa--gfx950"
.text
.globl gated_mix__spectral_fnet__dense_activation_squared_relu__prompt_kernel
.p2align 8
.type gated_mix__spectral_fnet__dense_activation_squared_relu__prompt_kernel,@function
gated_mix__spectral_fnet__dense_activation_squared_relu__prompt_kernel:
    s_cmp_ge_u32 s2, 256
    s_cbranch_scc1 gated_mix__spectral_fnet__dense_activation_squared_relu__prompt_kernel_end
    s_load_dwordx8 s[36:43], s[0:1], 48
    s_load_dwordx8 s[44:51], s[0:1], 80
    s_load_dwordx2 s[52:53], s[0:1], 0
    s_getreg_b32 s60, hwreg(HW_REG_XCC_ID)
    v_lshrrev_b32 v2, 6, v0
    v_and_b32 v1, 63, v0
    v_readfirstlane_b32 s3, v2
    s_and_b32 s60, s60, 7
    s_and_b32 s4, s3, 3
    s_and_b32 s58, s4, 1
    s_lshr_b32 s59, s4, 1
    s_waitcnt lgkmcnt(0)
    s_mov_b32 s28, s48
    s_and_b32 s29, s49, 0xffff
    s_mov_b32 s30, 256
    s_mov_b32 s31, 0x00020000
    s_mov_b32 s8, s52
    s_and_b32 s9, s53, 0xffff
    s_mov_b32 s10, 4194304
    s_mov_b32 s11, 0x00020000
    s_mov_b32 s96, s60
    s_and_b32 s6, s2, 7
    s_lshr_b32 s7, s2, 3
    s_lshl_b32 s5, s6, 5
    s_add_u32 s5, s5, s7
    s_and_b32 s60, s7, 1
    s_lshl_b32 s56, s6, 1
    s_add_u32 s56, s56, s60
    s_lshr_b32 s57, s7, 1
    s_bfe_u32 s74, s7, 0x10001
    s_lshr_b32 s75, s7, 2
    s_cmp_ge_u32 s3, 4
    s_cbranch_scc1 gated_mix__spectral_fnet__dense_activation_squared_relu__prompt_kernel_aux0
    s_lshl_b32 s61, s5, 14
    s_lshl_b32 s62, s4, 12
    s_add_u32 s61, s61, s62
    v_lshlrev_b32 v6, 4, v1
    s_add_u32 m0, s62, 118784
    s_nop 0
    buffer_load_dwordx4 v6, s[8:11], s61 offen offset:0 lds
    buffer_load_dwordx4 v6, s[8:11], s61 offen offset:1024 lds
    buffer_load_dwordx4 v6, s[8:11], s61 offen offset:2048 lds
    buffer_load_dwordx4 v6, s[8:11], s61 offen offset:3072 lds
gated_mix__spectral_fnet__dense_activation_squared_relu__prompt_kernel_aux0:
    s_mov_b32 s12, s36
    s_and_b32 s13, s37, 0xffff
    s_mov_b32 s14, 7340032
    s_mov_b32 s15, 0x00020000
    s_mov_b32 s16, s40
    s_and_b32 s17, s41, 0xffff
    s_mov_b32 s18, 7340032
    s_mov_b32 s19, 0x00020000
    s_mov_b32 s20, s50
    s_and_b32 s21, s51, 0xffff
    s_mov_b32 s22, 134217728
    s_mov_b32 s23, 0x00020000
    s_mov_b32 s24, s46
    s_and_b32 s25, s47, 0xffff
    s_mov_b32 s26, 4194304
    s_mov_b32 s27, 0x00020000
    s_cmp_ge_u32 s3, 4
    s_cbranch_scc1 gated_mix__spectral_fnet__dense_activation_squared_relu__prompt_kernel_aux
    s_setprio 2
    s_mov_b32 s32, s44
    s_and_b32 s33, s45, 0xffff
    s_mov_b32 s34, 2048
    s_mov_b32 s35, 0x00020000
    v_lshlrev_b32 v7, 5, v1
    buffer_load_dwordx4 v[128:131], v7, s[32:35], 0 offen
    buffer_load_dwordx4 v[132:135], v7, s[32:35], 0 offen offset:16
    v_and_b32 v2, 31, v1
    v_cvt_f32_u32 v2, v2
    v_mul_f32 v2, 0x3d000000, v2
    v_lshrrev_b32 v3, 5, v1
    v_cvt_f32_u32 v3, v3
    v_mul_f32 v3, 4.0, v3
    v_mul_f32 v3, v3, v2
    v_mul_f32 v4, 0x40a00000, v2
    v_fract_f32 v5, v3
    v_cos_f32 v96, v5
    v_sin_f32 v112, v5
    v_add_f32 v3, v3, v2
    v_fract_f32 v5, v3
    v_cos_f32 v97, v5
    v_sin_f32 v113, v5
    v_add_f32 v3, v3, v2
    v_fract_f32 v5, v3
    v_cos_f32 v98, v5
    v_sin_f32 v114, v5
    v_add_f32 v3, v3, v2
    v_fract_f32 v5, v3
    v_cos_f32 v99, v5
    v_sin_f32 v115, v5
    v_add_f32 v3, v3, v4
    v_fract_f32 v5, v3
    v_cos_f32 v100, v5
    v_sin_f32 v116, v5
    v_add_f32 v3, v3, v2
    v_fract_f32 v5, v3
    v_cos_f32 v101, v5
    v_sin_f32 v117, v5
    v_add_f32 v3, v3, v2
    v_fract_f32 v5, v3
    v_cos_f32 v102, v5
    v_sin_f32 v118, v5
    v_add_f32 v3, v3, v2
    v_fract_f32 v5, v3
    v_cos_f32 v103, v5
    v_sin_f32 v119, v5
    v_add_f32 v3, v3, v4
    v_fract_f32 v5, v3
    v_cos_f32 v104, v5
    v_sin_f32 v120, v5
    v_add_f32 v3, v3, v2
    v_fract_f32 v5, v3
    v_cos_f32 v105, v5
    v_sin_f32 v121, v5
    v_add_f32 v3, v3, v2
    v_fract_f32 v5, v3
    v_cos_f32 v106, v5
    v_sin_f32 v122, v5
    v_add_f32 v3, v3, v2
    v_fract_f32 v5, v3
    v_cos_f32 v107, v5
    v_sin_f32 v123, v5
    v_add_f32 v3, v3, v4
    v_fract_f32 v5, v3
    v_cos_f32 v108, v5
    v_sin_f32 v124, v5
    v_add_f32 v3, v3, v2
    v_fract_f32 v5, v3
    v_cos_f32 v109, v5
    v_sin_f32 v125, v5
    v_add_f32 v3, v3, v2
    v_fract_f32 v5, v3
    v_cos_f32 v110, v5
    v_sin_f32 v126, v5
    v_add_f32 v3, v3, v2
    v_fract_f32 v5, v3
    v_cos_f32 v111, v5
    v_sin_f32 v127, v5
    s_nop 0
    v_cvt_pk_bf16_f32 v16, v96, v97
    v_cvt_pk_bf16_f32 v24, v112, v113
    v_cvt_pk_bf16_f32 v17, v98, v99
    v_cvt_pk_bf16_f32 v25, v114, v115
    v_cvt_pk_bf16_f32 v18, v100, v101
    v_cvt_pk_bf16_f32 v26, v116, v117
    v_cvt_pk_bf16_f32 v19, v102, v103
    v_cvt_pk_bf16_f32 v27, v118, v119
    v_cvt_pk_bf16_f32 v20, v104, v105
    v_cvt_pk_bf16_f32 v28, v120, v121
    v_cvt_pk_bf16_f32 v21, v106, v107
    v_cvt_pk_bf16_f32 v29, v122, v123
    v_cvt_pk_bf16_f32 v22, v108, v109
    v_cvt_pk_bf16_f32 v30, v124, v125
    v_cvt_pk_bf16_f32 v23, v110, v111
    v_cvt_pk_bf16_f32 v31, v126, v127
    v_xor_b32 v32, 0x80008000, v24
    v_xor_b32 v33, 0x80008000, v25
    v_xor_b32 v34, 0x80008000, v26
    v_xor_b32 v35, 0x80008000, v27
    v_xor_b32 v36, 0x80008000, v28
    v_xor_b32 v37, 0x80008000, v29
    v_xor_b32 v38, 0x80008000, v30
    v_xor_b32 v39, 0x80008000, v31
    v_and_b32 v2, 31, v1
    v_cvt_f32_u32 v2, v2
    v_mul_f32 v2, 0x3a800000, v2
    v_lshrrev_b32 v3, 5, v1
    v_cvt_f32_u32 v3, v3
    v_mul_f32 v3, 4.0, v3
    v_mul_f32 v3, v3, v2
    v_mul_f32 v4, 0x40a00000, v2
    v_cos_f32 v96, v3
    v_sin_f32 v112, v3
    v_add_f32 v3, v3, v2
    v_cos_f32 v97, v3
    v_sin_f32 v113, v3
    v_add_f32 v3, v3, v2
    v_cos_f32 v98, v3
    v_sin_f32 v114, v3
    v_add_f32 v3, v3, v2
    v_cos_f32 v99, v3
    v_sin_f32 v115, v3
    v_add_f32 v3, v3, v4
    v_cos_f32 v100, v3
    v_sin_f32 v116, v3
    v_add_f32 v3, v3, v2
    v_cos_f32 v101, v3
    v_sin_f32 v117, v3
    v_add_f32 v3, v3, v2
    v_cos_f32 v102, v3
    v_sin_f32 v118, v3
    v_add_f32 v3, v3, v2
    v_cos_f32 v103, v3
    v_sin_f32 v119, v3
    v_add_f32 v3, v3, v4
    v_cos_f32 v104, v3
    v_sin_f32 v120, v3
    v_add_f32 v3, v3, v2
    v_cos_f32 v105, v3
    v_sin_f32 v121, v3
    v_add_f32 v3, v3, v2
    v_cos_f32 v106, v3
    v_sin_f32 v122, v3
    v_add_f32 v3, v3, v2
    v_cos_f32 v107, v3
    v_sin_f32 v123, v3
    v_add_f32 v3, v3, v4
    v_cos_f32 v108, v3
    v_sin_f32 v124, v3
    v_add_f32 v3, v3, v2
    v_cos_f32 v109, v3
    v_sin_f32 v125, v3
    v_add_f32 v3, v3, v2
    v_cos_f32 v110, v3
    v_sin_f32 v126, v3
    v_add_f32 v3, v3, v2
    v_cos_f32 v111, v3
    v_sin_f32 v127, v3
    s_lshl_b32 s61, s4, 12
    s_add_u32 s61, s61, 118784
    v_lshrrev_b32 v2, 5, v1
    v_bfe_u32 v3, v1, 2, 2
    v_lshl_add_u32 v2, v2, 2, v3
    v_lshlrev_b32 v2, 6, v2
    v_bfe_u32 v3, v1, 4, 1
    v_lshlrev_b32 v3, 5, v3
    v_and_b32 v4, 3, v1
    v_lshlrev_b32 v4, 3, v4
    v_add3_u32 v8, v2, v3, v4
    v_add_u32 v8, s61, v8
    v_lshlrev_b32 v9, 5, v1
    v_add_u32 v9, s61, v9
    v_and_b32 v2, 31, v1
    v_lshlrev_b32 v2, 4, v2
    v_lshrrev_b32 v3, 5, v1
    v_lshlrev_b32 v3, 11, v3
    s_lshl_b32 s60, s4, 2
    s_add_u32 s60, s60, 147456
    v_add3_u32 v10, v2, v3, s60
    s_mov_b32 s32, s38
    s_and_b32 s33, s39, 0xffff
    s_mov_b32 s34, 7168
    s_mov_b32 s35, 0x00020000
    v_lshrrev_b32 v7, 4, v1
    v_lshlrev_b32 v7, 3, v7
    s_mul_i32 s60, s57, 448
    s_mul_i32 s61, s59, 224
    s_add_u32 s60, s60, s61
    buffer_load_dwordx2 v[160:161], v7, s[32:35], s60 offen offset:0
    buffer_load_dwordx2 v[162:163], v7, s[32:35], s60 offen offset:32
    buffer_load_dwordx2 v[164:165], v7, s[32:35], s60 offen offset:64
    buffer_load_dwordx2 v[166:167], v7, s[32:35], s60 offen offset:96
    buffer_load_dwordx2 v[168:169], v7, s[32:35], s60 offen offset:128
    buffer_load_dwordx2 v[170:171], v7, s[32:35], s60 offen offset:160
    buffer_load_dwordx2 v[172:173], v7, s[32:35], s60 offen offset:192
    s_mov_b32 s32, s42
    s_and_b32 s33, s43, 0xffff
    s_mov_b32 s34, 2048
    s_mov_b32 s35, 0x00020000
    s_lshl_b32 s60, s75, 8
    s_lshl_b32 s61, s59, 7
    s_add_u32 s60, s60, s61
    s_lshl_b32 s61, s74, 6
    s_add_u32 s60, s60, s61
    buffer_load_dwordx2 v[246:247], v7, s[32:35], s60 offen offset:0
    buffer_load_dwordx2 v[248:249], v7, s[32:35], s60 offen offset:32
    s_waitcnt vmcnt(11)
    ds_read_b64_tr_b16 v[40:41], v8 offset:0
    ds_read_b64_tr_b16 v[42:43], v8 offset:512
    ds_read_b64_tr_b16 v[44:45], v8 offset:1024
    ds_read_b64_tr_b16 v[46:47], v8 offset:1536
    ds_read_b64_tr_b16 v[48:49], v8 offset:2048
    ds_read_b64_tr_b16 v[50:51], v8 offset:2560
    ds_read_b64_tr_b16 v[52:53], v8 offset:3072
    ds_read_b64_tr_b16 v[54:55], v8 offset:3584
    ds_read_b128 v[136:139], v9
    ds_read_b128 v[140:143], v9 offset:16
    ds_read_b128 v[144:147], v9 offset:2048
    ds_read_b128 v[148:151], v9 offset:2064
    s_waitcnt lgkmcnt(4)
    v_mfma_f32_32x32x16_bf16 v[64:79], v[40:43], v[16:19], 0
    v_mfma_f32_32x32x16_bf16 v[80:95], v[48:51], v[16:19], 0
    v_mfma_f32_32x32x16_bf16 v[64:79], v[44:47], v[20:23], v[64:79]
    v_mfma_f32_32x32x16_bf16 v[80:95], v[52:55], v[20:23], v[80:95]
    v_mfma_f32_32x32x16_bf16 v[64:79], v[48:51], v[24:27], v[64:79]
    v_mfma_f32_32x32x16_bf16 v[80:95], v[40:43], v[32:35], v[80:95]
    v_mfma_f32_32x32x16_bf16 v[64:79], v[52:55], v[28:31], v[64:79]
    v_mfma_f32_32x32x16_bf16 v[80:95], v[44:47], v[36:39], v[80:95]
    s_waitcnt vmcnt(9) lgkmcnt(0)
    v_mov_b32 v152, 0
    v_mov_b32 v153, 0
    v_dot2_f32_bf16 v152, v136, v128, v152
    v_dot2_f32_bf16 v153, v144, v128, v153
    v_dot2_f32_bf16 v152, v137, v129, v152
    v_dot2_f32_bf16 v153, v145, v129, v153
    v_dot2_f32_bf16 v152, v138, v130, v152
    v_dot2_f32_bf16 v153, v146, v130, v153
    v_dot2_f32_bf16 v152, v139, v131, v152
    v_dot2_f32_bf16 v153, v147, v131, v153
    v_dot2_f32_bf16 v152, v140, v132, v152
    v_dot2_f32_bf16 v153, v148, v132, v153
    v_dot2_f32_bf16 v152, v141, v133, v152
    v_dot2_f32_bf16 v153, v149, v133, v153
    v_dot2_f32_bf16 v152, v142, v134, v152
    v_dot2_f32_bf16 v153, v150, v134, v153
    v_dot2_f32_bf16 v152, v143, v135, v152
    v_dot2_f32_bf16 v153, v151, v135, v153
    s_nop 1
    v_add_f32_dpp v152, v152, v152 row_shr:1 row_mask:0xf bank_mask:0xf
    v_add_f32_dpp v153, v153, v153 row_shr:1 row_mask:0xf bank_mask:0xf
    s_nop 1
    v_add_f32_dpp v152, v152, v152 row_shr:2 row_mask:0xf bank_mask:0xf
    v_add_f32_dpp v153, v153, v153 row_shr:2 row_mask:0xf bank_mask:0xf
    s_nop 1
    v_add_f32_dpp v152, v152, v152 row_shr:4 row_mask:0xf bank_mask:0xf
    v_add_f32_dpp v153, v153, v153 row_shr:4 row_mask:0xf bank_mask:0xf
    s_nop 1
    v_add_f32_dpp v152, v152, v152 row_shr:8 row_mask:0xf bank_mask:0xf
    v_add_f32_dpp v153, v153, v153 row_shr:8 row_mask:0xf bank_mask:0xf
    s_nop 1
    v_add_f32_dpp v152, v152, v152 row_bcast:15 row_mask:0xa bank_mask:0xf
    v_add_f32_dpp v153, v153, v153 row_bcast:15 row_mask:0xa bank_mask:0xf
    s_nop 1
    v_add_f32_dpp v152, v152, v152 row_bcast:31 row_mask:0xc bank_mask:0xf
    v_add_f32_dpp v153, v153, v153 row_bcast:31 row_mask:0xc bank_mask:0xf
    v_pk_mul_f32 v[2:3], v[80:81], v[112:113]
    v_pk_mul_f32 v[4:5], v[64:65], v[112:113]
    v_pk_fma_f32 v[64:65], v[64:65], v[96:97], v[2:3]
    v_pk_fma_f32 v[80:81], v[80:81], v[96:97], v[4:5] neg_lo:[0,0,1] neg_hi:[0,0,1]
    v_cvt_pk_bf16_f32 v40, v64, v65
    v_cvt_pk_bf16_f32 v48, v80, v81
    v_pk_mul_f32 v[2:3], v[82:83], v[114:115]
    v_pk_mul_f32 v[4:5], v[66:67], v[114:115]
    v_pk_fma_f32 v[66:67], v[66:67], v[98:99], v[2:3]
    v_pk_fma_f32 v[82:83], v[82:83], v[98:99], v[4:5] neg_lo:[0,0,1] neg_hi:[0,0,1]
    v_cvt_pk_bf16_f32 v41, v66, v67
    v_cvt_pk_bf16_f32 v49, v82, v83
    v_pk_mul_f32 v[2:3], v[84:85], v[116:117]
    v_pk_mul_f32 v[4:5], v[68:69], v[116:117]
    v_pk_fma_f32 v[68:69], v[68:69], v[100:101], v[2:3]
    v_pk_fma_f32 v[84:85], v[84:85], v[100:101], v[4:5] neg_lo:[0,0,1] neg_hi:[0,0,1]
    v_cvt_pk_bf16_f32 v42, v68, v69
    v_cvt_pk_bf16_f32 v50, v84, v85
    v_pk_mul_f32 v[2:3], v[86:87], v[118:119]
    v_pk_mul_f32 v[4:5], v[70:71], v[118:119]
    v_pk_fma_f32 v[70:71], v[70:71], v[102:103], v[2:3]
    v_pk_fma_f32 v[86:87], v[86:87], v[102:103], v[4:5] neg_lo:[0,0,1] neg_hi:[0,0,1]
    v_cvt_pk_bf16_f32 v43, v70, v71
    v_cvt_pk_bf16_f32 v51, v86, v87
    v_pk_mul_f32 v[2:3], v[88:89], v[120:121]
    v_pk_mul_f32 v[4:5], v[72:73], v[120:121]
    v_pk_fma_f32 v[72:73], v[72:73], v[104:105], v[2:3]
    v_pk_fma_f32 v[88:89], v[88:89], v[104:105], v[4:5] neg_lo:[0,0,1] neg_hi:[0,0,1]
    v_cvt_pk_bf16_f32 v44, v72, v73
    v_cvt_pk_bf16_f32 v52, v88, v89
    v_pk_mul_f32 v[2:3], v[90:91], v[122:123]
    v_pk_mul_f32 v[4:5], v[74:75], v[122:123]
    v_pk_fma_f32 v[74:75], v[74:75], v[106:107], v[2:3]
    v_pk_fma_f32 v[90:91], v[90:91], v[106:107], v[4:5] neg_lo:[0,0,1] neg_hi:[0,0,1]
    v_cvt_pk_bf16_f32 v45, v74, v75
    v_cvt_pk_bf16_f32 v53, v90, v91
    v_pk_mul_f32 v[2:3], v[92:93], v[124:125]
    v_pk_mul_f32 v[4:5], v[76:77], v[124:125]
    v_pk_fma_f32 v[76:77], v[76:77], v[108:109], v[2:3]
    v_pk_fma_f32 v[92:93], v[92:93], v[108:109], v[4:5] neg_lo:[0,0,1] neg_hi:[0,0,1]
    v_cvt_pk_bf16_f32 v46, v76, v77
    v_cvt_pk_bf16_f32 v54, v92, v93
    v_pk_mul_f32 v[2:3], v[94:95], v[126:127]
    v_pk_mul_f32 v[4:5], v[78:79], v[126:127]
    v_pk_fma_f32 v[78:79], v[78:79], v[110:111], v[2:3]
    v_pk_fma_f32 v[94:95], v[94:95], v[110:111], v[4:5] neg_lo:[0,0,1] neg_hi:[0,0,1]
    v_cvt_pk_bf16_f32 v47, v78, v79
    v_cvt_pk_bf16_f32 v55, v94, v95
    s_nop 1
    v_mfma_f32_32x32x16_bf16 v[64:79], v[16:19], v[40:43], 0
    v_mfma_f32_32x32x16_bf16 v[80:95], v[16:19], v[48:51], 0
    v_mfma_f32_32x32x16_bf16 v[64:79], v[20:23], v[44:47], v[64:79]
    v_mfma_f32_32x32x16_bf16 v[80:95], v[20:23], v[52:55], v[80:95]
    v_mfma_f32_32x32x16_bf16 v[64:79], v[24:27], v[48:51], v[64:79]
    v_mfma_f32_32x32x16_bf16 v[80:95], v[32:35], v[40:43], v[80:95]
    v_mfma_f32_32x32x16_bf16 v[64:79], v[28:31], v[52:55], v[64:79]
    v_mfma_f32_32x32x16_bf16 v[80:95], v[36:39], v[44:47], v[80:95]
    v_mul_f32 v152, 0xbfb8aa3b, v152
    v_exp_f32 v152, v152
    s_nop 0
    v_add_f32 v152, 1.0, v152
    v_rcp_f32 v152, v152
    v_mul_f32 v153, 0xbfb8aa3b, v153
    v_exp_f32 v153, v153
    s_nop 0
    v_add_f32 v153, 1.0, v153
    v_rcp_f32 v153, v153
    s_lshl_b32 s60, s5, 5
    s_lshl_b32 s61, s4, 3
    s_add_u32 s60, s60, s61
    s_add_u32 s60, s60, 25165824
    v_mov_b32 v11, s60
    v_cmp_eq_u32 vcc, 63, v1
    s_and_saveexec_b64 s[62:63], vcc
    buffer_store_dwordx2 v[152:153], v11, s[20:23], 0 offen sc1
    s_mov_b64 exec, s[62:63]
    s_nop 4
    v_cvt_pk_bf16_f32 v40, v64, v80
    ds_write_b32 v10, v40 offset:0
    v_cvt_pk_bf16_f32 v41, v65, v81
    ds_write_b32 v10, v41 offset:512
    v_cvt_pk_bf16_f32 v42, v66, v82
    ds_write_b32 v10, v42 offset:1024
    v_cvt_pk_bf16_f32 v43, v67, v83
    ds_write_b32 v10, v43 offset:1536
    v_cvt_pk_bf16_f32 v44, v68, v84
    ds_write_b32 v10, v44 offset:4096
    v_cvt_pk_bf16_f32 v45, v69, v85
    ds_write_b32 v10, v45 offset:4608
    v_cvt_pk_bf16_f32 v46, v70, v86
    ds_write_b32 v10, v46 offset:5120
    v_cvt_pk_bf16_f32 v47, v71, v87
    ds_write_b32 v10, v47 offset:5632
    v_cvt_pk_bf16_f32 v48, v72, v88
    ds_write_b32 v10, v48 offset:8192
    v_cvt_pk_bf16_f32 v49, v73, v89
    ds_write_b32 v10, v49 offset:8704
    v_cvt_pk_bf16_f32 v50, v74, v90
    ds_write_b32 v10, v50 offset:9216
    v_cvt_pk_bf16_f32 v51, v75, v91
    ds_write_b32 v10, v51 offset:9728
    v_cvt_pk_bf16_f32 v52, v76, v92
    ds_write_b32 v10, v52 offset:12288
    v_cvt_pk_bf16_f32 v53, v77, v93
    ds_write_b32 v10, v53 offset:12800
    v_cvt_pk_bf16_f32 v54, v78, v94
    ds_write_b32 v10, v54 offset:13312
    v_cvt_pk_bf16_f32 v55, v79, v95
    ds_write_b32 v10, v55 offset:13824
    s_waitcnt lgkmcnt(0)
    v_and_b32 v3, 15, v1
    v_lshrrev_b32 v7, 4, v1
    v_and_b32 v15, 7, v1
    v_xor_b32 v15, v15, v7
    v_lshlrev_b32 v15, 4, v15
    s_lshl_b32 s60, s58, 13
    v_lshlrev_b32 v4, 7, v3
    v_add_u32 v4, v4, v15
    v_add_u32 v240, s60, v4
    v_xor_b32 v241, 64, v240
    v_bfe_u32 v15, v1, 2, 2
    v_lshl_add_u32 v15, v7, 3, v15
    v_mul_u32_u24 v15, 448, v15
    v_and_b32 v5, 3, v1
    v_lshl_add_u32 v15, v5, 3, v15
    v_and_b32 v6, 1, v7
    v_lshlrev_b32 v6, 5, v6
    s_mul_i32 s60, s59, 224
    s_add_u32 s60, s60, 32768
    v_add_u32 v15, s60, v15
    v_add_u32 v13, v15, v6
    v_sub_u32 v14, v15, v6
    s_cmp_eq_u32 s59, 0
    s_cselect_b64 vcc, -1, 0
    s_nop 1
    v_cndmask_b32 v242, v14, v13, vcc
    v_cndmask_b32 v243, v13, v14, vcc
    s_mov_b32 s64, 0
    s_mov_b32 s65, 0
    s_mov_b32 s66, 16384
    s_mov_b32 s67, 4294950912
    s_mov_b32 s68, 28672
    s_mov_b32 s69, 4294881280
    s_waitcnt vmcnt(1)
    v_mov_b32 v96, v160
    v_mov_b32 v97, v161
    v_mov_b32 v98, v162
    v_mov_b32 v99, v163
    v_mov_b32 v100, v164
    v_mov_b32 v101, v165
    v_mov_b32 v102, v166
    v_mov_b32 v103, v167
    v_mov_b32 v104, v168
    v_mov_b32 v105, v169
    v_mov_b32 v106, v170
    v_mov_b32 v107, v171
    v_mov_b32 v108, v172
    v_mov_b32 v109, v173
    v_lshlrev_b32 v128, 16, v96
    v_and_b32 v129, 0xffff0000, v96
    v_lshlrev_b32 v130, 16, v97
    v_and_b32 v131, 0xffff0000, v97
    v_mov_b32 v132, v128
    v_mov_b32 v133, v129
    v_mov_b32 v134, v130
    v_mov_b32 v135, v131
    v_mov_b32 v136, v128
    v_mov_b32 v137, v129
    v_mov_b32 v138, v130
    v_mov_b32 v139, v131
    v_mov_b32 v140, v128
    v_mov_b32 v141, v129
    v_mov_b32 v142, v130
    v_mov_b32 v143, v131
    v_lshlrev_b32 v144, 16, v98
    v_and_b32 v145, 0xffff0000, v98
    v_lshlrev_b32 v146, 16, v99
    v_and_b32 v147, 0xffff0000, v99
    v_mov_b32 v148, v144
    v_mov_b32 v149, v145
    v_mov_b32 v150, v146
    v_mov_b32 v151, v147
    v_mov_b32 v152, v144
    v_mov_b32 v153, v145
    v_mov_b32 v154, v146
    v_mov_b32 v155, v147
    v_mov_b32 v156, v144
    v_mov_b32 v157, v145
    v_mov_b32 v158, v146
    v_mov_b32 v159, v147
    v_lshlrev_b32 v160, 16, v100
    v_and_b32 v161, 0xffff0000, v100
    v_lshlrev_b32 v162, 16, v101
    v_and_b32 v163, 0xffff0000, v101
    v_mov_b32 v164, v160
    v_mov_b32 v165, v161
    v_mov_b32 v166, v162
    v_mov_b32 v167, v163
    v_mov_b32 v168, v160
    v_mov_b32 v169, v161
    v_mov_b32 v170, v162
    v_mov_b32 v171, v163
    v_mov_b32 v172, v160
    v_mov_b32 v173, v161
    v_mov_b32 v174, v162
    v_mov_b32 v175, v163
    v_lshlrev_b32 v176, 16, v102
    v_and_b32 v177, 0xffff0000, v102
    v_lshlrev_b32 v178, 16, v103
    v_and_b32 v179, 0xffff0000, v103
    v_mov_b32 v180, v176
    v_mov_b32 v181, v177
    v_mov_b32 v182, v178
    v_mov_b32 v183, v179
    v_mov_b32 v184, v176
    v_mov_b32 v185, v177
    v_mov_b32 v186, v178
    v_mov_b32 v187, v179
    v_mov_b32 v188, v176
    v_mov_b32 v189, v177
    v_mov_b32 v190, v178
    v_mov_b32 v191, v179
    v_lshlrev_b32 v192, 16, v104
    v_and_b32 v193, 0xffff0000, v104
    v_lshlrev_b32 v194, 16, v105
    v_and_b32 v195, 0xffff0000, v105
    v_mov_b32 v196, v192
    v_mov_b32 v197, v193
    v_mov_b32 v198, v194
    v_mov_b32 v199, v195
    v_mov_b32 v200, v192
    v_mov_b32 v201, v193
    v_mov_b32 v202, v194
    v_mov_b32 v203, v195
    v_mov_b32 v204, v192
    v_mov_b32 v205, v193
    v_mov_b32 v206, v194
    v_mov_b32 v207, v195
    v_lshlrev_b32 v208, 16, v106
    v_and_b32 v209, 0xffff0000, v106
    v_lshlrev_b32 v210, 16, v107
    v_and_b32 v211, 0xffff0000, v107
    v_mov_b32 v212, v208
    v_mov_b32 v213, v209
    v_mov_b32 v214, v210
    v_mov_b32 v215, v211
    v_mov_b32 v216, v208
    v_mov_b32 v217, v209
    v_mov_b32 v218, v210
    v_mov_b32 v219, v211
    v_mov_b32 v220, v208
    v_mov_b32 v221, v209
    v_mov_b32 v222, v210
    v_mov_b32 v223, v211
    v_lshlrev_b32 v224, 16, v108
    v_and_b32 v225, 0xffff0000, v108
    v_lshlrev_b32 v226, 16, v109
    v_and_b32 v227, 0xffff0000, v109
    v_mov_b32 v228, v224
    v_mov_b32 v229, v225
    v_mov_b32 v230, v226
    v_mov_b32 v231, v227
    v_mov_b32 v232, v224
    v_mov_b32 v233, v225
    v_mov_b32 v234, v226
    v_mov_b32 v235, v227
    v_mov_b32 v236, v224
    v_mov_b32 v237, v225
    v_mov_b32 v238, v226
    v_mov_b32 v239, v227
    s_barrier
    ds_read_b128 v[16:19], v240 offset:0
    ds_read_b64_tr_b16 v[32:33], v242 offset:0
    ds_read_b64_tr_b16 v[34:35], v242 offset:1792
    ds_read_b128 v[20:23], v240 offset:2048
    ds_read_b128 v[24:27], v240 offset:4096
    ds_read_b128 v[28:31], v240 offset:6144
    ds_read_b64_tr_b16 v[36:37], v243 offset:32
    ds_read_b64_tr_b16 v[38:39], v243 offset:1824
    ds_read_b64_tr_b16 v[40:41], v242 offset:64
    ds_read_b64_tr_b16 v[42:43], v242 offset:1856
    ds_read_b64_tr_b16 v[44:45], v243 offset:96
    ds_read_b64_tr_b16 v[46:47], v243 offset:1888
    ds_read_b64_tr_b16 v[48:49], v242 offset:128
    ds_read_b64_tr_b16 v[50:51], v242 offset:1920
    ds_read_b64_tr_b16 v[52:53], v243 offset:160
    ds_read_b64_tr_b16 v[54:55], v243 offset:1952
    ds_read_b64_tr_b16 v[56:57], v242 offset:192
    ds_read_b64_tr_b16 v[58:59], v242 offset:1984
    s_mov_b32 s72, 15
    s_mov_b32 s79, 12
gated_mix__spectral_fnet__dense_activation_squared_relu__prompt_kernel_g1loop:
    s_cmp_eq_u32 s72, s79
    s_cbranch_scc1 gated_mix__spectral_fnet__dense_activation_squared_relu__prompt_kernel_g1evt
gated_mix__spectral_fnet__dense_activation_squared_relu__prompt_kernel_g1back:
    s_waitcnt lgkmcnt(0)
    v_mfma_f32_16x16x32_bf16 v[128:131], v[32:35], v[16:19], v[128:131]
    ds_read_b128 v[64:67], v241 offset:0
    v_mfma_f32_16x16x32_bf16 v[132:135], v[32:35], v[20:23], v[132:135]
    ds_read_b64_tr_b16 v[80:81], v242 offset:14336
    v_mfma_f32_16x16x32_bf16 v[136:139], v[32:35], v[24:27], v[136:139]
    ds_read_b64_tr_b16 v[82:83], v242 offset:16128
    v_mfma_f32_16x16x32_bf16 v[140:143], v[32:35], v[28:31], v[140:143]
    ds_read_b128 v[68:71], v241 offset:2048
    v_mfma_f32_16x16x32_bf16 v[144:147], v[36:39], v[16:19], v[144:147]
    ds_read_b128 v[72:75], v241 offset:4096
    v_mfma_f32_16x16x32_bf16 v[148:151], v[36:39], v[20:23], v[148:151]
    ds_read_b128 v[76:79], v241 offset:6144
    v_mfma_f32_16x16x32_bf16 v[152:155], v[36:39], v[24:27], v[152:155]
    ds_read_b64_tr_b16 v[84:85], v243 offset:14368
    v_mfma_f32_16x16x32_bf16 v[156:159], v[36:39], v[28:31], v[156:159]
    ds_read_b64_tr_b16 v[86:87], v243 offset:16160
    v_mfma_f32_16x16x32_bf16 v[160:163], v[40:43], v[16:19], v[160:163]
    ds_read_b64_tr_b16 v[88:89], v242 offset:14400
    v_mfma_f32_16x16x32_bf16 v[164:167], v[40:43], v[20:23], v[164:167]
    ds_read_b64_tr_b16 v[90:91], v242 offset:16192
    v_mfma_f32_16x16x32_bf16 v[168:171], v[40:43], v[24:27], v[168:171]
    ds_read_b64_tr_b16 v[92:93], v243 offset:14432
    v_mfma_f32_16x16x32_bf16 v[172:175], v[40:43], v[28:31], v[172:175]
    ds_read_b64_tr_b16 v[94:95], v243 offset:16224
    v_mfma_f32_16x16x32_bf16 v[176:179], v[44:47], v[16:19], v[176:179]
    ds_read_b64_tr_b16 v[96:97], v242 offset:14464
    v_mfma_f32_16x16x32_bf16 v[180:183], v[44:47], v[20:23], v[180:183]
    ds_read_b64_tr_b16 v[98:99], v242 offset:16256
    v_mfma_f32_16x16x32_bf16 v[184:187], v[44:47], v[24:27], v[184:187]
    ds_read_b64_tr_b16 v[100:101], v243 offset:14496
    v_mfma_f32_16x16x32_bf16 v[188:191], v[44:47], v[28:31], v[188:191]
    ds_read_b64_tr_b16 v[102:103], v243 offset:16288
    v_mfma_f32_16x16x32_bf16 v[192:195], v[48:51], v[16:19], v[192:195]
    ds_read_b64_tr_b16 v[104:105], v242 offset:14528
    v_mfma_f32_16x16x32_bf16 v[196:199], v[48:51], v[20:23], v[196:199]
    ds_read_b64_tr_b16 v[106:107], v242 offset:16320
    v_mfma_f32_16x16x32_bf16 v[200:203], v[48:51], v[24:27], v[200:203]
    s_add_u32 s64, s64, 16384
    s_cmp_eq_u32 s64, 32768
    s_cselect_b32 s70, s67, s66
    s_cselect_b32 s64, 0, s64
    v_mfma_f32_16x16x32_bf16 v[204:207], v[48:51], v[28:31], v[204:207]
    s_add_u32 s65, s65, 28672
    s_cmp_eq_u32 s65, 114688
    s_cselect_b32 s71, s69, s68
    s_cselect_b32 s65, 0, s65
    v_mfma_f32_16x16x32_bf16 v[208:211], v[52:55], v[16:19], v[208:211]
    v_add_u32 v240, s70, v240
    v_add_u32 v241, s70, v241
    v_add_u32 v242, s71, v242
    v_add_u32 v243, s71, v243
    v_mfma_f32_16x16x32_bf16 v[212:215], v[52:55], v[20:23], v[212:215]
    v_mfma_f32_16x16x32_bf16 v[216:219], v[52:55], v[24:27], v[216:219]
    v_mfma_f32_16x16x32_bf16 v[220:223], v[52:55], v[28:31], v[220:223]
    v_mfma_f32_16x16x32_bf16 v[224:227], v[56:59], v[16:19], v[224:227]
    v_mfma_f32_16x16x32_bf16 v[228:231], v[56:59], v[20:23], v[228:231]
    s_waitcnt lgkmcnt(0)
    s_barrier
    v_mfma_f32_16x16x32_bf16 v[232:235], v[56:59], v[24:27], v[232:235]
    v_mfma_f32_16x16x32_bf16 v[236:239], v[56:59], v[28:31], v[236:239]
    v_mfma_f32_16x16x32_bf16 v[128:131], v[80:83], v[64:67], v[128:131]
    ds_read_b128 v[16:19], v240 offset:0
    v_mfma_f32_16x16x32_bf16 v[132:135], v[80:83], v[68:71], v[132:135]
    ds_read_b64_tr_b16 v[32:33], v242 offset:0
    v_mfma_f32_16x16x32_bf16 v[136:139], v[80:83], v[72:75], v[136:139]
    ds_read_b64_tr_b16 v[34:35], v242 offset:1792
    v_mfma_f32_16x16x32_bf16 v[140:143], v[80:83], v[76:79], v[140:143]
    ds_read_b128 v[20:23], v240 offset:2048
    v_mfma_f32_16x16x32_bf16 v[144:147], v[84:87], v[64:67], v[144:147]
    ds_read_b128 v[24:27], v240 offset:4096
    v_mfma_f32_16x16x32_bf16 v[148:151], v[84:87], v[68:71], v[148:151]
    ds_read_b128 v[28:31], v240 offset:6144
    v_mfma_f32_16x16x32_bf16 v[152:155], v[84:87], v[72:75], v[152:155]
    ds_read_b64_tr_b16 v[36:37], v243 offset:32
    v_mfma_f32_16x16x32_bf16 v[156:159], v[84:87], v[76:79], v[156:159]
    ds_read_b64_tr_b16 v[38:39], v243 offset:1824
    v_mfma_f32_16x16x32_bf16 v[160:163], v[88:91], v[64:67], v[160:163]
    ds_read_b64_tr_b16 v[40:41], v242 offset:64
    v_mfma_f32_16x16x32_bf16 v[164:167], v[88:91], v[68:71], v[164:167]
    ds_read_b64_tr_b16 v[42:43], v242 offset:1856
    v_mfma_f32_16x16x32_bf16 v[168:171], v[88:91], v[72:75], v[168:171]
    ds_read_b64_tr_b16 v[44:45], v243 offset:96
    v_mfma_f32_16x16x32_bf16 v[172:175], v[88:91], v[76:79], v[172:175]
    ds_read_b64_tr_b16 v[46:47], v243 offset:1888
    v_mfma_f32_16x16x32_bf16 v[176:179], v[92:95], v[64:67], v[176:179]
    ds_read_b64_tr_b16 v[48:49], v242 offset:128
    v_mfma_f32_16x16x32_bf16 v[180:183], v[92:95], v[68:71], v[180:183]
    ds_read_b64_tr_b16 v[50:51], v242 offset:1920
    v_mfma_f32_16x16x32_bf16 v[184:187], v[92:95], v[72:75], v[184:187]
    ds_read_b64_tr_b16 v[52:53], v243 offset:160
    v_mfma_f32_16x16x32_bf16 v[188:191], v[92:95], v[76:79], v[188:191]
    ds_read_b64_tr_b16 v[54:55], v243 offset:1952
    v_mfma_f32_16x16x32_bf16 v[192:195], v[96:99], v[64:67], v[192:195]
    ds_read_b64_tr_b16 v[56:57], v242 offset:192
    v_mfma_f32_16x16x32_bf16 v[196:199], v[96:99], v[68:71], v[196:199]
    ds_read_b64_tr_b16 v[58:59], v242 offset:1984
    v_mfma_f32_16x16x32_bf16 v[200:203], v[96:99], v[72:75], v[200:203]
    v_mfma_f32_16x16x32_bf16 v[204:207], v[96:99], v[76:79], v[204:207]
    v_mfma_f32_16x16x32_bf16 v[208:211], v[100:103], v[64:67], v[208:211]
    v_mfma_f32_16x16x32_bf16 v[212:215], v[100:103], v[68:71], v[212:215]
    v_mfma_f32_16x16x32_bf16 v[216:219], v[100:103], v[72:75], v[216:219]
    v_mfma_f32_16x16x32_bf16 v[220:223], v[100:103], v[76:79], v[220:223]
    v_mfma_f32_16x16x32_bf16 v[224:227], v[104:107], v[64:67], v[224:227]
    v_mfma_f32_16x16x32_bf16 v[228:231], v[104:107], v[68:71], v[228:231]
    v_mfma_f32_16x16x32_bf16 v[232:235], v[104:107], v[72:75], v[232:235]
    v_mfma_f32_16x16x32_bf16 v[236:239], v[104:107], v[76:79], v[236:239]
    s_sub_u32 s72, s72, 1
    s_cmp_lg_u32 s72, 0
    s_cbranch_scc1 gated_mix__spectral_fnet__dense_activation_squared_relu__prompt_kernel_g1loop
    v_mov_b32 v8, 61504
    ds_read_b32 v10, v8
    s_waitcnt lgkmcnt(0)
    v_mfma_f32_16x16x32_bf16 v[128:131], v[32:35], v[16:19], v[128:131]
    ds_read_b128 v[64:67], v241 offset:0
    v_mfma_f32_16x16x32_bf16 v[132:135], v[32:35], v[20:23], v[132:135]
    ds_read_b64_tr_b16 v[80:81], v242 offset:14336
    v_mfma_f32_16x16x32_bf16 v[136:139], v[32:35], v[24:27], v[136:139]
    ds_read_b64_tr_b16 v[82:83], v242 offset:16128
    v_mfma_f32_16x16x32_bf16 v[140:143], v[32:35], v[28:31], v[140:143]
    ds_read_b128 v[68:71], v241 offset:2048
    v_mfma_f32_16x16x32_bf16 v[144:147], v[36:39], v[16:19], v[144:147]
    ds_read_b128 v[72:75], v241 offset:4096
    v_mfma_f32_16x16x32_bf16 v[148:151], v[36:39], v[20:23], v[148:151]
    ds_read_b128 v[76:79], v241 offset:6144
    v_mfma_f32_16x16x32_bf16 v[152:155], v[36:39], v[24:27], v[152:155]
    ds_read_b64_tr_b16 v[84:85], v243 offset:14368
    v_mfma_f32_16x16x32_bf16 v[156:159], v[36:39], v[28:31], v[156:159]
    ds_read_b64_tr_b16 v[86:87], v243 offset:16160
    v_mfma_f32_16x16x32_bf16 v[160:163], v[40:43], v[16:19], v[160:163]
    ds_read_b64_tr_b16 v[88:89], v242 offset:14400
    v_mfma_f32_16x16x32_bf16 v[164:167], v[40:43], v[20:23], v[164:167]
    ds_read_b64_tr_b16 v[90:91], v242 offset:16192
    v_mfma_f32_16x16x32_bf16 v[168:171], v[40:43], v[24:27], v[168:171]
    ds_read_b64_tr_b16 v[92:93], v243 offset:14432
    v_mfma_f32_16x16x32_bf16 v[172:175], v[40:43], v[28:31], v[172:175]
    ds_read_b64_tr_b16 v[94:95], v243 offset:16224
    v_mfma_f32_16x16x32_bf16 v[176:179], v[44:47], v[16:19], v[176:179]
    ds_read_b64_tr_b16 v[96:97], v242 offset:14464
    v_mfma_f32_16x16x32_bf16 v[180:183], v[44:47], v[20:23], v[180:183]
    ds_read_b64_tr_b16 v[98:99], v242 offset:16256
    v_mfma_f32_16x16x32_bf16 v[184:187], v[44:47], v[24:27], v[184:187]
    ds_read_b64_tr_b16 v[100:101], v243 offset:14496
    v_mfma_f32_16x16x32_bf16 v[188:191], v[44:47], v[28:31], v[188:191]
    ds_read_b64_tr_b16 v[102:103], v243 offset:16288
    v_mfma_f32_16x16x32_bf16 v[192:195], v[48:51], v[16:19], v[192:195]
    ds_read_b64_tr_b16 v[104:105], v242 offset:14528
    v_mfma_f32_16x16x32_bf16 v[196:199], v[48:51], v[20:23], v[196:199]
    ds_read_b64_tr_b16 v[106:107], v242 offset:16320
    v_mfma_f32_16x16x32_bf16 v[200:203], v[48:51], v[24:27], v[200:203]
    s_add_u32 s64, s64, 16384
    s_cmp_eq_u32 s64, 32768
    s_cselect_b32 s70, s67, s66
    s_cselect_b32 s64, 0, s64
    v_mfma_f32_16x16x32_bf16 v[204:207], v[48:51], v[28:31], v[204:207]
    s_add_u32 s65, s65, 28672
    s_cmp_eq_u32 s65, 114688
    s_cselect_b32 s71, s69, s68
    s_cselect_b32 s65, 0, s65
    v_mfma_f32_16x16x32_bf16 v[208:211], v[52:55], v[16:19], v[208:211]
    v_add_u32 v240, s70, v240
    v_add_u32 v241, s70, v241
    v_add_u32 v242, s71, v242
    v_add_u32 v243, s71, v243
    v_mfma_f32_16x16x32_bf16 v[212:215], v[52:55], v[20:23], v[212:215]
    v_mfma_f32_16x16x32_bf16 v[216:219], v[52:55], v[24:27], v[216:219]
    v_mfma_f32_16x16x32_bf16 v[220:223], v[52:55], v[28:31], v[220:223]
    v_mfma_f32_16x16x32_bf16 v[224:227], v[56:59], v[16:19], v[224:227]
    v_mfma_f32_16x16x32_bf16 v[228:231], v[56:59], v[20:23], v[228:231]
    s_waitcnt lgkmcnt(0)
    s_barrier
    v_mfma_f32_16x16x32_bf16 v[232:235], v[56:59], v[24:27], v[232:235]
    v_mfma_f32_16x16x32_bf16 v[236:239], v[56:59], v[28:31], v[236:239]
    v_mfma_f32_16x16x32_bf16 v[128:131], v[80:83], v[64:67], v[128:131]
    v_mfma_f32_16x16x32_bf16 v[132:135], v[80:83], v[68:71], v[132:135]
    v_mfma_f32_16x16x32_bf16 v[136:139], v[80:83], v[72:75], v[136:139]
    v_mfma_f32_16x16x32_bf16 v[140:143], v[80:83], v[76:79], v[140:143]
    v_mfma_f32_16x16x32_bf16 v[144:147], v[84:87], v[64:67], v[144:147]
    v_mfma_f32_16x16x32_bf16 v[148:151], v[84:87], v[68:71], v[148:151]
    v_mfma_f32_16x16x32_bf16 v[152:155], v[84:87], v[72:75], v[152:155]
    v_mfma_f32_16x16x32_bf16 v[156:159], v[84:87], v[76:79], v[156:159]
    v_mfma_f32_16x16x32_bf16 v[160:163], v[88:91], v[64:67], v[160:163]
    v_mfma_f32_16x16x32_bf16 v[164:167], v[88:91], v[68:71], v[164:167]
    v_mfma_f32_16x16x32_bf16 v[168:171], v[88:91], v[72:75], v[168:171]
    v_mfma_f32_16x16x32_bf16 v[172:175], v[88:91], v[76:79], v[172:175]
    v_mfma_f32_16x16x32_bf16 v[176:179], v[92:95], v[64:67], v[176:179]
    v_mfma_f32_16x16x32_bf16 v[180:183], v[92:95], v[68:71], v[180:183]
    v_mfma_f32_16x16x32_bf16 v[184:187], v[92:95], v[72:75], v[184:187]
    v_mfma_f32_16x16x32_bf16 v[188:191], v[92:95], v[76:79], v[188:191]
    v_mfma_f32_16x16x32_bf16 v[192:195], v[96:99], v[64:67], v[192:195]
    v_mfma_f32_16x16x32_bf16 v[196:199], v[96:99], v[68:71], v[196:199]
    v_mfma_f32_16x16x32_bf16 v[200:203], v[96:99], v[72:75], v[200:203]
    v_mfma_f32_16x16x32_bf16 v[204:207], v[96:99], v[76:79], v[204:207]
    v_mfma_f32_16x16x32_bf16 v[208:211], v[100:103], v[64:67], v[208:211]
    v_mfma_f32_16x16x32_bf16 v[212:215], v[100:103], v[68:71], v[212:215]
    v_mfma_f32_16x16x32_bf16 v[216:219], v[100:103], v[72:75], v[216:219]
    v_mfma_f32_16x16x32_bf16 v[220:223], v[100:103], v[76:79], v[220:223]
    v_mfma_f32_16x16x32_bf16 v[224:227], v[104:107], v[64:67], v[224:227]
    v_mfma_f32_16x16x32_bf16 v[228:231], v[104:107], v[68:71], v[228:231]
    v_mfma_f32_16x16x32_bf16 v[232:235], v[104:107], v[72:75], v[232:235]
    v_mfma_f32_16x16x32_bf16 v[236:239], v[104:107], v[76:79], v[236:239]
    v_readfirstlane_b32 s54, v10
    v_and_b32 v3, 15, v1
    v_lshrrev_b32 v7, 4, v1
    s_lshl_b32 s60, s56, 7
    s_lshl_b32 s61, s58, 6
    s_add_u32 s60, s60, s61
    v_add_u32 v12, s60, v3
    v_and_b32 v8, 1, v7
    v_lshrrev_b32 v9, 1, v7
    v_lshlrev_b32 v3, 4, v3
    v_lshl_add_u32 v10, v8, 1, v9
    v_lshl_add_u32 v10, v10, 11, v3
    v_lshlrev_b32 v9, 11, v9
    v_lshlrev_b32 v8, 8, v8
    v_add3_u32 v11, v9, v8, v3
    s_mul_i32 s62, s56, 917504
    s_mul_i32 s60, s57, 57344
    s_add_u32 s62, s62, s60
    s_mul_i32 s60, s59, 28672
    s_add_u32 s62, s62, s60
    s_lshl_b32 s60, s58, 10
    s_add_u32 s62, s62, s60
    s_add_u32 s62, s62, 65536
    s_cmp_eq_u32 s54, 0
    s_cbranch_scc0 gated_mix__spectral_fnet__dense_activation_squared_relu__prompt_kernel_epi_slow
    v_mul_f32 v128, v128, |v128|
    v_mul_f32 v129, v129, |v129|
    v_mul_f32 v130, v130, |v130|
    v_mul_f32 v131, v131, |v131|
    v_mul_f32 v144, v144, |v144|
    v_mul_f32 v145, v145, |v145|
    v_mul_f32 v146, v146, |v146|
    v_mul_f32 v147, v147, |v147|
    v_cvt_pk_bf16_f32 v16, v128, v129
    v_cvt_pk_bf16_f32 v17, v130, v131
    v_cvt_pk_bf16_f32 v18, v144, v145
    v_cvt_pk_bf16_f32 v19, v146, v147
    v_pk_max_i16 v16, v16, 0
    v_pk_max_i16 v17, v17, 0
    v_pk_max_i16 v18, v18, 0
    v_pk_max_i16 v19, v19, 0
    s_add_u32 s60, s62, 0
    s_nop 0
    v_permlane16_swap_b32 v16, v18
    v_permlane16_swap_b32 v17, v19
    buffer_store_dwordx4 v[16:19], v10, s[20:23], s60 offen offset:0
    v_mul_f32 v160, v160, |v160|
    v_mul_f32 v161, v161, |v161|
    v_mul_f32 v162, v162, |v162|
    v_mul_f32 v163, v163, |v163|
    v_mul_f32 v176, v176, |v176|
    v_mul_f32 v177, v177, |v177|
    v_mul_f32 v178, v178, |v178|
    v_mul_f32 v179, v179, |v179|
    v_cvt_pk_bf16_f32 v20, v160, v161
    v_cvt_pk_bf16_f32 v21, v162, v163
    v_cvt_pk_bf16_f32 v22, v176, v177
    v_cvt_pk_bf16_f32 v23, v178, v179
    v_pk_max_i16 v20, v20, 0
    v_pk_max_i16 v21, v21, 0
    v_pk_max_i16 v22, v22, 0
    v_pk_max_i16 v23, v23, 0
    s_add_u32 s60, s62, 8192
    s_nop 0
    v_permlane16_swap_b32 v20, v22
    v_permlane16_swap_b32 v21, v23
    buffer_store_dwordx4 v[20:23], v10, s[20:23], s60 offen offset:0
    v_mul_f32 v192, v192, |v192|
    v_mul_f32 v193, v193, |v193|
    v_mul_f32 v194, v194, |v194|
    v_mul_f32 v195, v195, |v195|
    v_mul_f32 v208, v208, |v208|
    v_mul_f32 v209, v209, |v209|
    v_mul_f32 v210, v210, |v210|
    v_mul_f32 v211, v211, |v211|
    v_cvt_pk_bf16_f32 v24, v192, v193
    v_cvt_pk_bf16_f32 v25, v194, v195
    v_cvt_pk_bf16_f32 v26, v208, v209
    v_cvt_pk_bf16_f32 v27, v210, v211
    v_pk_max_i16 v24, v24, 0
    v_pk_max_i16 v25, v25, 0
    v_pk_max_i16 v26, v26, 0
    v_pk_max_i16 v27, v27, 0
    s_add_u32 s60, s62, 16384
    s_nop 0
    v_permlane16_swap_b32 v24, v26
    v_permlane16_swap_b32 v25, v27
    buffer_store_dwordx4 v[24:27], v10, s[20:23], s60 offen offset:0
    v_mul_f32 v132, v132, |v132|
    v_mul_f32 v133, v133, |v133|
    v_mul_f32 v134, v134, |v134|
    v_mul_f32 v135, v135, |v135|
    v_mul_f32 v148, v148, |v148|
    v_mul_f32 v149, v149, |v149|
    v_mul_f32 v150, v150, |v150|
    v_mul_f32 v151, v151, |v151|
    v_cvt_pk_bf16_f32 v28, v132, v133
    v_cvt_pk_bf16_f32 v29, v134, v135
    v_cvt_pk_bf16_f32 v30, v148, v149
    v_cvt_pk_bf16_f32 v31, v150, v151
    v_pk_max_i16 v28, v28, 0
    v_pk_max_i16 v29, v29, 0
    v_pk_max_i16 v30, v30, 0
    v_pk_max_i16 v31, v31, 0
    s_add_u32 s60, s62, 0
    s_nop 0
    v_permlane16_swap_b32 v28, v30
    v_permlane16_swap_b32 v29, v31
    buffer_store_dwordx4 v[28:31], v10, s[20:23], s60 offen offset:256
    v_mul_f32 v164, v164, |v164|
    v_mul_f32 v165, v165, |v165|
    v_mul_f32 v166, v166, |v166|
    v_mul_f32 v167, v167, |v167|
    v_mul_f32 v180, v180, |v180|
    v_mul_f32 v181, v181, |v181|
    v_mul_f32 v182, v182, |v182|
    v_mul_f32 v183, v183, |v183|
    v_cvt_pk_bf16_f32 v32, v164, v165
    v_cvt_pk_bf16_f32 v33, v166, v167
    v_cvt_pk_bf16_f32 v34, v180, v181
    v_cvt_pk_bf16_f32 v35, v182, v183
    v_pk_max_i16 v32, v32, 0
    v_pk_max_i16 v33, v33, 0
    v_pk_max_i16 v34, v34, 0
    v_pk_max_i16 v35, v35, 0
    s_add_u32 s60, s62, 8192
    s_nop 0
    v_permlane16_swap_b32 v32, v34
    v_permlane16_swap_b32 v33, v35
    buffer_store_dwordx4 v[32:35], v10, s[20:23], s60 offen offset:256
    v_mul_f32 v196, v196, |v196|
    v_mul_f32 v197, v197, |v197|
    v_mul_f32 v198, v198, |v198|
    v_mul_f32 v199, v199, |v199|
    v_mul_f32 v212, v212, |v212|
    v_mul_f32 v213, v213, |v213|
    v_mul_f32 v214, v214, |v214|
    v_mul_f32 v215, v215, |v215|
    v_cvt_pk_bf16_f32 v36, v196, v197
    v_cvt_pk_bf16_f32 v37, v198, v199
    v_cvt_pk_bf16_f32 v38, v212, v213
    v_cvt_pk_bf16_f32 v39, v214, v215
    v_pk_max_i16 v36, v36, 0
    v_pk_max_i16 v37, v37, 0
    v_pk_max_i16 v38, v38, 0
    v_pk_max_i16 v39, v39, 0
    s_add_u32 s60, s62, 16384
    s_nop 0
    v_permlane16_swap_b32 v36, v38
    v_permlane16_swap_b32 v37, v39
    buffer_store_dwordx4 v[36:39], v10, s[20:23], s60 offen offset:256
    v_mul_f32 v136, v136, |v136|
    v_mul_f32 v137, v137, |v137|
    v_mul_f32 v138, v138, |v138|
    v_mul_f32 v139, v139, |v139|
    v_mul_f32 v152, v152, |v152|
    v_mul_f32 v153, v153, |v153|
    v_mul_f32 v154, v154, |v154|
    v_mul_f32 v155, v155, |v155|
    v_cvt_pk_bf16_f32 v40, v136, v137
    v_cvt_pk_bf16_f32 v41, v138, v139
    v_cvt_pk_bf16_f32 v42, v152, v153
    v_cvt_pk_bf16_f32 v43, v154, v155
    v_pk_max_i16 v40, v40, 0
    v_pk_max_i16 v41, v41, 0
    v_pk_max_i16 v42, v42, 0
    v_pk_max_i16 v43, v43, 0
    s_add_u32 s60, s62, 0
    s_nop 0
    v_permlane16_swap_b32 v40, v42
    v_permlane16_swap_b32 v41, v43
    buffer_store_dwordx4 v[40:43], v10, s[20:23], s60 offen offset:512
    v_mul_f32 v168, v168, |v168|
    v_mul_f32 v169, v169, |v169|
    v_mul_f32 v170, v170, |v170|
    v_mul_f32 v171, v171, |v171|
    v_mul_f32 v184, v184, |v184|
    v_mul_f32 v185, v185, |v185|
    v_mul_f32 v186, v186, |v186|
    v_mul_f32 v187, v187, |v187|
    v_cvt_pk_bf16_f32 v44, v168, v169
    v_cvt_pk_bf16_f32 v45, v170, v171
    v_cvt_pk_bf16_f32 v46, v184, v185
    v_cvt_pk_bf16_f32 v47, v186, v187
    v_pk_max_i16 v44, v44, 0
    v_pk_max_i16 v45, v45, 0
    v_pk_max_i16 v46, v46, 0
    v_pk_max_i16 v47, v47, 0
    s_add_u32 s60, s62, 8192
    s_nop 0
    v_permlane16_swap_b32 v44, v46
    v_permlane16_swap_b32 v45, v47
    buffer_store_dwordx4 v[44:47], v10, s[20:23], s60 offen offset:512
    v_mul_f32 v200, v200, |v200|
    v_mul_f32 v201, v201, |v201|
    v_mul_f32 v202, v202, |v202|
    v_mul_f32 v203, v203, |v203|
    v_mul_f32 v216, v216, |v216|
    v_mul_f32 v217, v217, |v217|
    v_mul_f32 v218, v218, |v218|
    v_mul_f32 v219, v219, |v219|
    v_cvt_pk_bf16_f32 v48, v200, v201
    v_cvt_pk_bf16_f32 v49, v202, v203
    v_cvt_pk_bf16_f32 v50, v216, v217
    v_cvt_pk_bf16_f32 v51, v218, v219
    v_pk_max_i16 v48, v48, 0
    v_pk_max_i16 v49, v49, 0
    v_pk_max_i16 v50, v50, 0
    v_pk_max_i16 v51, v51, 0
    s_add_u32 s60, s62, 16384
    s_nop 0
    v_permlane16_swap_b32 v48, v50
    v_permlane16_swap_b32 v49, v51
    buffer_store_dwordx4 v[48:51], v10, s[20:23], s60 offen offset:512
    v_mul_f32 v140, v140, |v140|
    v_mul_f32 v141, v141, |v141|
    v_mul_f32 v142, v142, |v142|
    v_mul_f32 v143, v143, |v143|
    v_mul_f32 v156, v156, |v156|
    v_mul_f32 v157, v157, |v157|
    v_mul_f32 v158, v158, |v158|
    v_mul_f32 v159, v159, |v159|
    v_cvt_pk_bf16_f32 v52, v140, v141
    v_cvt_pk_bf16_f32 v53, v142, v143
    v_cvt_pk_bf16_f32 v54, v156, v157
    v_cvt_pk_bf16_f32 v55, v158, v159
    v_pk_max_i16 v52, v52, 0
    v_pk_max_i16 v53, v53, 0
    v_pk_max_i16 v54, v54, 0
    v_pk_max_i16 v55, v55, 0
    s_add_u32 s60, s62, 0
    s_nop 0
    v_permlane16_swap_b32 v52, v54
    v_permlane16_swap_b32 v53, v55
    buffer_store_dwordx4 v[52:55], v10, s[20:23], s60 offen offset:768
    v_mul_f32 v172, v172, |v172|
    v_mul_f32 v173, v173, |v173|
    v_mul_f32 v174, v174, |v174|
    v_mul_f32 v175, v175, |v175|
    v_mul_f32 v188, v188, |v188|
    v_mul_f32 v189, v189, |v189|
    v_mul_f32 v190, v190, |v190|
    v_mul_f32 v191, v191, |v191|
    v_cvt_pk_bf16_f32 v56, v172, v173
    v_cvt_pk_bf16_f32 v57, v174, v175
    v_cvt_pk_bf16_f32 v58, v188, v189
    v_cvt_pk_bf16_f32 v59, v190, v191
    v_pk_max_i16 v56, v56, 0
    v_pk_max_i16 v57, v57, 0
    v_pk_max_i16 v58, v58, 0
    v_pk_max_i16 v59, v59, 0
    s_add_u32 s60, s62, 8192
    s_nop 0
    v_permlane16_swap_b32 v56, v58
    v_permlane16_swap_b32 v57, v59
    buffer_store_dwordx4 v[56:59], v10, s[20:23], s60 offen offset:768
    v_mul_f32 v204, v204, |v204|
    v_mul_f32 v205, v205, |v205|
    v_mul_f32 v206, v206, |v206|
    v_mul_f32 v207, v207, |v207|
    v_mul_f32 v220, v220, |v220|
    v_mul_f32 v221, v221, |v221|
    v_mul_f32 v222, v222, |v222|
    v_mul_f32 v223, v223, |v223|
    v_cvt_pk_bf16_f32 v60, v204, v205
    v_cvt_pk_bf16_f32 v61, v206, v207
    v_cvt_pk_bf16_f32 v62, v220, v221
    v_cvt_pk_bf16_f32 v63, v222, v223
    v_pk_max_i16 v60, v60, 0
    v_pk_max_i16 v61, v61, 0
    v_pk_max_i16 v62, v62, 0
    v_pk_max_i16 v63, v63, 0
    s_add_u32 s60, s62, 16384
    s_nop 0
    v_permlane16_swap_b32 v60, v62
    v_permlane16_swap_b32 v61, v63
    buffer_store_dwordx4 v[60:63], v10, s[20:23], s60 offen offset:768
    v_mul_f32 v224, v224, |v224|
    v_mul_f32 v225, v225, |v225|
    v_mul_f32 v226, v226, |v226|
    v_mul_f32 v227, v227, |v227|
    v_mul_f32 v228, v228, |v228|
    v_mul_f32 v229, v229, |v229|
    v_mul_f32 v230, v230, |v230|
    v_mul_f32 v231, v231, |v231|
    v_cvt_pk_bf16_f32 v64, v224, v225
    v_cvt_pk_bf16_f32 v65, v226, v227
    v_cvt_pk_bf16_f32 v66, v228, v229
    v_cvt_pk_bf16_f32 v67, v230, v231
    v_pk_max_i16 v64, v64, 0
    v_pk_max_i16 v65, v65, 0
    v_pk_max_i16 v66, v66, 0
    v_pk_max_i16 v67, v67, 0
    s_add_u32 s60, s62, 24576
    s_nop 0
    v_permlane16_swap_b32 v64, v66
    v_permlane16_swap_b32 v65, v67
    buffer_store_dwordx4 v[64:67], v11, s[20:23], s60 offen offset:0
    v_mul_f32 v232, v232, |v232|
    v_mul_f32 v233, v233, |v233|
    v_mul_f32 v234, v234, |v234|
    v_mul_f32 v235, v235, |v235|
    v_mul_f32 v236, v236, |v236|
    v_mul_f32 v237, v237, |v237|
    v_mul_f32 v238, v238, |v238|
    v_mul_f32 v239, v239, |v239|
    v_cvt_pk_bf16_f32 v68, v232, v233
    v_cvt_pk_bf16_f32 v69, v234, v235
    v_cvt_pk_bf16_f32 v70, v236, v237
    v_cvt_pk_bf16_f32 v71, v238, v239
    v_pk_max_i16 v68, v68, 0
    v_pk_max_i16 v69, v69, 0
    v_pk_max_i16 v70, v70, 0
    v_pk_max_i16 v71, v71, 0
    s_add_u32 s60, s62, 24576
    s_nop 0
    v_permlane16_swap_b32 v68, v70
    v_permlane16_swap_b32 v69, v71
    buffer_store_dwordx4 v[68:71], v11, s[20:23], s60 offen offset:512
    s_branch gated_mix__spectral_fnet__dense_activation_squared_relu__prompt_kernel_epi_done
gated_mix__spectral_fnet__dense_activation_squared_relu__prompt_kernel_epi_slow:
    v_mul_f32 v128, v128, |v128|
    v_mul_f32 v129, v129, |v129|
    v_mul_f32 v130, v130, |v130|
    v_mul_f32 v131, v131, |v131|
    v_mul_f32 v144, v144, |v144|
    v_mul_f32 v145, v145, |v145|
    v_mul_f32 v146, v146, |v146|
    v_mul_f32 v147, v147, |v147|
    v_cvt_pk_bf16_f32 v16, v128, v129
    v_cvt_pk_bf16_f32 v17, v130, v131
    v_cvt_pk_bf16_f32 v18, v144, v145
    v_cvt_pk_bf16_f32 v19, v146, v147
    v_pk_max_i16 v16, v16, 0
    v_pk_max_i16 v17, v17, 0
    v_pk_max_i16 v18, v18, 0
    v_pk_max_i16 v19, v19, 0
    s_add_u32 s60, s62, 0
    s_nop 0
    v_permlane16_swap_b32 v16, v18
    v_permlane16_swap_b32 v17, v19
    buffer_store_dwordx4 v[16:19], v10, s[20:23], s60 offen offset:0 sc1
    v_mul_f32 v160, v160, |v160|
    v_mul_f32 v161, v161, |v161|
    v_mul_f32 v162, v162, |v162|
    v_mul_f32 v163, v163, |v163|
    v_mul_f32 v176, v176, |v176|
    v_mul_f32 v177, v177, |v177|
    v_mul_f32 v178, v178, |v178|
    v_mul_f32 v179, v179, |v179|
    v_cvt_pk_bf16_f32 v20, v160, v161
    v_cvt_pk_bf16_f32 v21, v162, v163
    v_cvt_pk_bf16_f32 v22, v176, v177
    v_cvt_pk_bf16_f32 v23, v178, v179
    v_pk_max_i16 v20, v20, 0
    v_pk_max_i16 v21, v21, 0
    v_pk_max_i16 v22, v22, 0
    v_pk_max_i16 v23, v23, 0
    s_add_u32 s60, s62, 8192
    s_nop 0
    v_permlane16_swap_b32 v20, v22
    v_permlane16_swap_b32 v21, v23
    buffer_store_dwordx4 v[20:23], v10, s[20:23], s60 offen offset:0 sc1
    v_mul_f32 v192, v192, |v192|
    v_mul_f32 v193, v193, |v193|
    v_mul_f32 v194, v194, |v194|
    v_mul_f32 v195, v195, |v195|
    v_mul_f32 v208, v208, |v208|
    v_mul_f32 v209, v209, |v209|
    v_mul_f32 v210, v210, |v210|
    v_mul_f32 v211, v211, |v211|
    v_cvt_pk_bf16_f32 v24, v192, v193
    v_cvt_pk_bf16_f32 v25, v194, v195
    v_cvt_pk_bf16_f32 v26, v208, v209
    v_cvt_pk_bf16_f32 v27, v210, v211
    v_pk_max_i16 v24, v24, 0
    v_pk_max_i16 v25, v25, 0
    v_pk_max_i16 v26, v26, 0
    v_pk_max_i16 v27, v27, 0
    s_add_u32 s60, s62, 16384
    s_nop 0
    v_permlane16_swap_b32 v24, v26
    v_permlane16_swap_b32 v25, v27
    buffer_store_dwordx4 v[24:27], v10, s[20:23], s60 offen offset:0 sc1
    v_mul_f32 v132, v132, |v132|
    v_mul_f32 v133, v133, |v133|
    v_mul_f32 v134, v134, |v134|
    v_mul_f32 v135, v135, |v135|
    v_mul_f32 v148, v148, |v148|
    v_mul_f32 v149, v149, |v149|
    v_mul_f32 v150, v150, |v150|
    v_mul_f32 v151, v151, |v151|
    v_cvt_pk_bf16_f32 v28, v132, v133
    v_cvt_pk_bf16_f32 v29, v134, v135
    v_cvt_pk_bf16_f32 v30, v148, v149
    v_cvt_pk_bf16_f32 v31, v150, v151
    v_pk_max_i16 v28, v28, 0
    v_pk_max_i16 v29, v29, 0
    v_pk_max_i16 v30, v30, 0
    v_pk_max_i16 v31, v31, 0
    s_add_u32 s60, s62, 0
    s_nop 0
    v_permlane16_swap_b32 v28, v30
    v_permlane16_swap_b32 v29, v31
    buffer_store_dwordx4 v[28:31], v10, s[20:23], s60 offen offset:256 sc1
    v_mul_f32 v164, v164, |v164|
    v_mul_f32 v165, v165, |v165|
    v_mul_f32 v166, v166, |v166|
    v_mul_f32 v167, v167, |v167|
    v_mul_f32 v180, v180, |v180|
    v_mul_f32 v181, v181, |v181|
    v_mul_f32 v182, v182, |v182|
    v_mul_f32 v183, v183, |v183|
    v_cvt_pk_bf16_f32 v32, v164, v165
    v_cvt_pk_bf16_f32 v33, v166, v167
    v_cvt_pk_bf16_f32 v34, v180, v181
    v_cvt_pk_bf16_f32 v35, v182, v183
    v_pk_max_i16 v32, v32, 0
    v_pk_max_i16 v33, v33, 0
    v_pk_max_i16 v34, v34, 0
    v_pk_max_i16 v35, v35, 0
    s_add_u32 s60, s62, 8192
    s_nop 0
    v_permlane16_swap_b32 v32, v34
    v_permlane16_swap_b32 v33, v35
    buffer_store_dwordx4 v[32:35], v10, s[20:23], s60 offen offset:256 sc1
    v_mul_f32 v196, v196, |v196|
    v_mul_f32 v197, v197, |v197|
    v_mul_f32 v198, v198, |v198|
    v_mul_f32 v199, v199, |v199|
    v_mul_f32 v212, v212, |v212|
    v_mul_f32 v213, v213, |v213|
    v_mul_f32 v214, v214, |v214|
    v_mul_f32 v215, v215, |v215|
    v_cvt_pk_bf16_f32 v36, v196, v197
    v_cvt_pk_bf16_f32 v37, v198, v199
    v_cvt_pk_bf16_f32 v38, v212, v213
    v_cvt_pk_bf16_f32 v39, v214, v215
    v_pk_max_i16 v36, v36, 0
    v_pk_max_i16 v37, v37, 0
    v_pk_max_i16 v38, v38, 0
    v_pk_max_i16 v39, v39, 0
    s_add_u32 s60, s62, 16384
    s_nop 0
    v_permlane16_swap_b32 v36, v38
    v_permlane16_swap_b32 v37, v39
    buffer_store_dwordx4 v[36:39], v10, s[20:23], s60 offen offset:256 sc1
    v_mul_f32 v136, v136, |v136|
    v_mul_f32 v137, v137, |v137|
    v_mul_f32 v138, v138, |v138|
    v_mul_f32 v139, v139, |v139|
    v_mul_f32 v152, v152, |v152|
    v_mul_f32 v153, v153, |v153|
    v_mul_f32 v154, v154, |v154|
    v_mul_f32 v155, v155, |v155|
    v_cvt_pk_bf16_f32 v40, v136, v137
    v_cvt_pk_bf16_f32 v41, v138, v139
    v_cvt_pk_bf16_f32 v42, v152, v153
    v_cvt_pk_bf16_f32 v43, v154, v155
    v_pk_max_i16 v40, v40, 0
    v_pk_max_i16 v41, v41, 0
    v_pk_max_i16 v42, v42, 0
    v_pk_max_i16 v43, v43, 0
    s_add_u32 s60, s62, 0
    s_nop 0
    v_permlane16_swap_b32 v40, v42
    v_permlane16_swap_b32 v41, v43
    buffer_store_dwordx4 v[40:43], v10, s[20:23], s60 offen offset:512 sc1
    v_mul_f32 v168, v168, |v168|
    v_mul_f32 v169, v169, |v169|
    v_mul_f32 v170, v170, |v170|
    v_mul_f32 v171, v171, |v171|
    v_mul_f32 v184, v184, |v184|
    v_mul_f32 v185, v185, |v185|
    v_mul_f32 v186, v186, |v186|
    v_mul_f32 v187, v187, |v187|
    v_cvt_pk_bf16_f32 v44, v168, v169
    v_cvt_pk_bf16_f32 v45, v170, v171
    v_cvt_pk_bf16_f32 v46, v184, v185
    v_cvt_pk_bf16_f32 v47, v186, v187
    v_pk_max_i16 v44, v44, 0
    v_pk_max_i16 v45, v45, 0
    v_pk_max_i16 v46, v46, 0
    v_pk_max_i16 v47, v47, 0
    s_add_u32 s60, s62, 8192
    s_nop 0
    v_permlane16_swap_b32 v44, v46
    v_permlane16_swap_b32 v45, v47
    buffer_store_dwordx4 v[44:47], v10, s[20:23], s60 offen offset:512 sc1
    v_mul_f32 v200, v200, |v200|
    v_mul_f32 v201, v201, |v201|
    v_mul_f32 v202, v202, |v202|
    v_mul_f32 v203, v203, |v203|
    v_mul_f32 v216, v216, |v216|
    v_mul_f32 v217, v217, |v217|
    v_mul_f32 v218, v218, |v218|
    v_mul_f32 v219, v219, |v219|
    v_cvt_pk_bf16_f32 v48, v200, v201
    v_cvt_pk_bf16_f32 v49, v202, v203
    v_cvt_pk_bf16_f32 v50, v216, v217
    v_cvt_pk_bf16_f32 v51, v218, v219
    v_pk_max_i16 v48, v48, 0
    v_pk_max_i16 v49, v49, 0
    v_pk_max_i16 v50, v50, 0
    v_pk_max_i16 v51, v51, 0
    s_add_u32 s60, s62, 16384
    s_nop 0
    v_permlane16_swap_b32 v48, v50
    v_permlane16_swap_b32 v49, v51
    buffer_store_dwordx4 v[48:51], v10, s[20:23], s60 offen offset:512 sc1
    v_mul_f32 v140, v140, |v140|
    v_mul_f32 v141, v141, |v141|
    v_mul_f32 v142, v142, |v142|
    v_mul_f32 v143, v143, |v143|
    v_mul_f32 v156, v156, |v156|
    v_mul_f32 v157, v157, |v157|
    v_mul_f32 v158, v158, |v158|
    v_mul_f32 v159, v159, |v159|
    v_cvt_pk_bf16_f32 v52, v140, v141
    v_cvt_pk_bf16_f32 v53, v142, v143
    v_cvt_pk_bf16_f32 v54, v156, v157
    v_cvt_pk_bf16_f32 v55, v158, v159
    v_pk_max_i16 v52, v52, 0
    v_pk_max_i16 v53, v53, 0
    v_pk_max_i16 v54, v54, 0
    v_pk_max_i16 v55, v55, 0
    s_add_u32 s60, s62, 0
    s_nop 0
    v_permlane16_swap_b32 v52, v54
    v_permlane16_swap_b32 v53, v55
    buffer_store_dwordx4 v[52:55], v10, s[20:23], s60 offen offset:768 sc1
    v_mul_f32 v172, v172, |v172|
    v_mul_f32 v173, v173, |v173|
    v_mul_f32 v174, v174, |v174|
    v_mul_f32 v175, v175, |v175|
    v_mul_f32 v188, v188, |v188|
    v_mul_f32 v189, v189, |v189|
    v_mul_f32 v190, v190, |v190|
    v_mul_f32 v191, v191, |v191|
    v_cvt_pk_bf16_f32 v56, v172, v173
    v_cvt_pk_bf16_f32 v57, v174, v175
    v_cvt_pk_bf16_f32 v58, v188, v189
    v_cvt_pk_bf16_f32 v59, v190, v191
    v_pk_max_i16 v56, v56, 0
    v_pk_max_i16 v57, v57, 0
    v_pk_max_i16 v58, v58, 0
    v_pk_max_i16 v59, v59, 0
    s_add_u32 s60, s62, 8192
    s_nop 0
    v_permlane16_swap_b32 v56, v58
    v_permlane16_swap_b32 v57, v59
    buffer_store_dwordx4 v[56:59], v10, s[20:23], s60 offen offset:768 sc1
    v_mul_f32 v204, v204, |v204|
    v_mul_f32 v205, v205, |v205|
    v_mul_f32 v206, v206, |v206|
    v_mul_f32 v207, v207, |v207|
    v_mul_f32 v220, v220, |v220|
    v_mul_f32 v221, v221, |v221|
    v_mul_f32 v222, v222, |v222|
    v_mul_f32 v223, v223, |v223|
    v_cvt_pk_bf16_f32 v60, v204, v205
    v_cvt_pk_bf16_f32 v61, v206, v207
    v_cvt_pk_bf16_f32 v62, v220, v221
    v_cvt_pk_bf16_f32 v63, v222, v223
    v_pk_max_i16 v60, v60, 0
    v_pk_max_i16 v61, v61, 0
    v_pk_max_i16 v62, v62, 0
    v_pk_max_i16 v63, v63, 0
    s_add_u32 s60, s62, 16384
    s_nop 0
    v_permlane16_swap_b32 v60, v62
    v_permlane16_swap_b32 v61, v63
    buffer_store_dwordx4 v[60:63], v10, s[20:23], s60 offen offset:768 sc1
    v_mul_f32 v224, v224, |v224|
    v_mul_f32 v225, v225, |v225|
    v_mul_f32 v226, v226, |v226|
    v_mul_f32 v227, v227, |v227|
    v_mul_f32 v228, v228, |v228|
    v_mul_f32 v229, v229, |v229|
    v_mul_f32 v230, v230, |v230|
    v_mul_f32 v231, v231, |v231|
    v_cvt_pk_bf16_f32 v64, v224, v225
    v_cvt_pk_bf16_f32 v65, v226, v227
    v_cvt_pk_bf16_f32 v66, v228, v229
    v_cvt_pk_bf16_f32 v67, v230, v231
    v_pk_max_i16 v64, v64, 0
    v_pk_max_i16 v65, v65, 0
    v_pk_max_i16 v66, v66, 0
    v_pk_max_i16 v67, v67, 0
    s_add_u32 s60, s62, 24576
    s_nop 0
    v_permlane16_swap_b32 v64, v66
    v_permlane16_swap_b32 v65, v67
    buffer_store_dwordx4 v[64:67], v11, s[20:23], s60 offen offset:0 sc1
    v_mul_f32 v232, v232, |v232|
    v_mul_f32 v233, v233, |v233|
    v_mul_f32 v234, v234, |v234|
    v_mul_f32 v235, v235, |v235|
    v_mul_f32 v236, v236, |v236|
    v_mul_f32 v237, v237, |v237|
    v_mul_f32 v238, v238, |v238|
    v_mul_f32 v239, v239, |v239|
    v_cvt_pk_bf16_f32 v68, v232, v233
    v_cvt_pk_bf16_f32 v69, v234, v235
    v_cvt_pk_bf16_f32 v70, v236, v237
    v_cvt_pk_bf16_f32 v71, v238, v239
    v_pk_max_i16 v68, v68, 0
    v_pk_max_i16 v69, v69, 0
    v_pk_max_i16 v70, v70, 0
    v_pk_max_i16 v71, v71, 0
    s_add_u32 s60, s62, 24576
    s_nop 0
    v_permlane16_swap_b32 v68, v70
    v_permlane16_swap_b32 v69, v71
    buffer_store_dwordx4 v[68:71], v11, s[20:23], s60 offen offset:512 sc1
    s_waitcnt vmcnt(0)
gated_mix__spectral_fnet__dense_activation_squared_relu__prompt_kernel_epi_done:
    v_mov_b32 v254, v12
    v_lshlrev_b32 v9, 2, v12
    s_mov_b32 s60, 25165824
    buffer_load_dword v250, v9, s[20:23], s60 offen offset:0 sc1
    buffer_load_dword v251, v9, s[20:23], s60 offen offset:64 sc1
    buffer_load_dword v252, v9, s[20:23], s60 offen offset:128 sc1
    buffer_load_dword v253, v9, s[20:23], s60 offen offset:192 sc1
    v_and_b32 v3, 15, v1
    v_lshrrev_b32 v7, 4, v1
    v_lshlrev_b32 v4, 4, v3
    v_lshl_add_u32 v4, v7, 11, v4
    s_lshl_b32 s60, s58, 10
    v_add_u32 v240, s60, v4
    v_add_u32 v241, 8192, v240
    v_bfe_u32 v15, v1, 2, 2
    v_lshl_add_u32 v9, v7, 3, v15
    v_lshlrev_b32 v9, 8, v9
    v_and_b32 v8, 1, v7
    v_lshl_or_b32 v15, v8, 2, v15
    s_lshl_b32 s60, s59, 2
    v_xor_b32 v15, s60, v15
    v_lshlrev_b32 v15, 5, v15
    v_and_b32 v8, 3, v1
    v_lshlrev_b32 v8, 3, v8
    v_add3_u32 v242, v9, v15, v8
    v_add_u32 v242, 81920, v242
    v_xor_b32 v243, 32, v242
    v_xor_b32 v244, 64, v242
    v_xor_b32 v245, 96, v242
    s_waitcnt vmcnt(4) lgkmcnt(0)
    s_barrier
    s_cmp_eq_u32 s74, 0
    s_cbranch_scc0 gated_mix__spectral_fnet__dense_activation_squared_relu__prompt_kernel_ini1
    v_lshlrev_b32 v128, 16, v246
    v_and_b32 v129, 0xffff0000, v246
    v_lshlrev_b32 v130, 16, v247
    v_and_b32 v131, 0xffff0000, v247
    v_mov_b32 v132, v128
    v_mov_b32 v133, v129
    v_mov_b32 v134, v130
    v_mov_b32 v135, v131
    v_mov_b32 v136, v128
    v_mov_b32 v137, v129
    v_mov_b32 v138, v130
    v_mov_b32 v139, v131
    v_mov_b32 v140, v128
    v_mov_b32 v141, v129
    v_mov_b32 v142, v130
    v_mov_b32 v143, v131
    v_lshlrev_b32 v144, 16, v248
    v_and_b32 v145, 0xffff0000, v248
    v_lshlrev_b32 v146, 16, v249
    v_and_b32 v147, 0xffff0000, v249
    v_mov_b32 v148, v144
    v_mov_b32 v149, v145
    v_mov_b32 v150, v146
    v_mov_b32 v151, v147
    v_mov_b32 v152, v144
    v_mov_b32 v153, v145
    v_mov_b32 v154, v146
    v_mov_b32 v155, v147
    v_mov_b32 v156, v144
    v_mov_b32 v157, v145
    v_mov_b32 v158, v146
    v_mov_b32 v159, v147
    v_mov_b32 v160, 0
    v_mov_b32 v161, 0
    v_mov_b32 v162, 0
    v_mov_b32 v163, 0
    v_mov_b32 v164, 0
    v_mov_b32 v165, 0
    v_mov_b32 v166, 0
    v_mov_b32 v167, 0
    v_mov_b32 v168, 0
    v_mov_b32 v169, 0
    v_mov_b32 v170, 0
    v_mov_b32 v171, 0
    v_mov_b32 v172, 0
    v_mov_b32 v173, 0
    v_mov_b32 v174, 0
    v_mov_b32 v175, 0
    v_mov_b32 v176, 0
    v_mov_b32 v177, 0
    v_mov_b32 v178, 0
    v_mov_b32 v179, 0
    v_mov_b32 v180, 0
    v_mov_b32 v181, 0
    v_mov_b32 v182, 0
    v_mov_b32 v183, 0
    v_mov_b32 v184, 0
    v_mov_b32 v185, 0
    v_mov_b32 v186, 0
    v_mov_b32 v187, 0
    v_mov_b32 v188, 0
    v_mov_b32 v189, 0
    v_mov_b32 v190, 0
    v_mov_b32 v191, 0
    s_branch gated_mix__spectral_fnet__dense_activation_squared_relu__prompt_kernel_ini2
gated_mix__spectral_fnet__dense_activation_squared_relu__prompt_kernel_ini1:
    v_mov_b32 v128, 0
    v_mov_b32 v129, 0
    v_mov_b32 v130, 0
    v_mov_b32 v131, 0
    v_mov_b32 v132, 0
    v_mov_b32 v133, 0
    v_mov_b32 v134, 0
    v_mov_b32 v135, 0
    v_mov_b32 v136, 0
    v_mov_b32 v137, 0
    v_mov_b32 v138, 0
    v_mov_b32 v139, 0
    v_mov_b32 v140, 0
    v_mov_b32 v141, 0
    v_mov_b32 v142, 0
    v_mov_b32 v143, 0
    v_mov_b32 v144, 0
    v_mov_b32 v145, 0
    v_mov_b32 v146, 0
    v_mov_b32 v147, 0
    v_mov_b32 v148, 0
    v_mov_b32 v149, 0
    v_mov_b32 v150, 0
    v_mov_b32 v151, 0
    v_mov_b32 v152, 0
    v_mov_b32 v153, 0
    v_mov_b32 v154, 0
    v_mov_b32 v155, 0
    v_mov_b32 v156, 0
    v_mov_b32 v157, 0
    v_mov_b32 v158, 0
    v_mov_b32 v159, 0
    v_lshlrev_b32 v160, 16, v246
    v_and_b32 v161, 0xffff0000, v246
    v_lshlrev_b32 v162, 16, v247
    v_and_b32 v163, 0xffff0000, v247
    v_mov_b32 v164, v160
    v_mov_b32 v165, v161
    v_mov_b32 v166, v162
    v_mov_b32 v167, v163
    v_mov_b32 v168, v160
    v_mov_b32 v169, v161
    v_mov_b32 v170, v162
    v_mov_b32 v171, v163
    v_mov_b32 v172, v160
    v_mov_b32 v173, v161
    v_mov_b32 v174, v162
    v_mov_b32 v175, v163
    v_lshlrev_b32 v176, 16, v248
    v_and_b32 v177, 0xffff0000, v248
    v_lshlrev_b32 v178, 16, v249
    v_and_b32 v179, 0xffff0000, v249
    v_mov_b32 v180, v176
    v_mov_b32 v181, v177
    v_mov_b32 v182, v178
    v_mov_b32 v183, v179
    v_mov_b32 v184, v176
    v_mov_b32 v185, v177
    v_mov_b32 v186, v178
    v_mov_b32 v187, v179
    v_mov_b32 v188, v176
    v_mov_b32 v189, v177
    v_mov_b32 v190, v178
    v_mov_b32 v191, v179
gated_mix__spectral_fnet__dense_activation_squared_relu__prompt_kernel_ini2:
    s_mov_b32 s64, 0
    s_mov_b32 s65, 0
    s_mov_b32 s66, 16384
    s_mov_b32 s67, 4294901760
    s_mov_b32 s68, 16384
    s_mov_b32 s69, 4294918144
    s_barrier
    s_barrier
    ds_read_b128 v[16:19], v240 offset:0
    ds_read_b64_tr_b16 v[32:33], v242 offset:0
    ds_read_b64_tr_b16 v[34:35], v242 offset:1024
    ds_read_b128 v[20:23], v240 offset:256
    ds_read_b128 v[24:27], v240 offset:512
    ds_read_b128 v[28:31], v240 offset:768
    ds_read_b64_tr_b16 v[36:37], v243 offset:0
    ds_read_b64_tr_b16 v[38:39], v243 offset:1024
    ds_read_b64_tr_b16 v[40:41], v244 offset:0
    ds_read_b64_tr_b16 v[42:43], v244 offset:1024
    ds_read_b64_tr_b16 v[44:45], v245 offset:0
    ds_read_b64_tr_b16 v[46:47], v245 offset:1024
    s_mov_b32 s72, 27
    s_mov_b32 s79, 18
gated_mix__spectral_fnet__dense_activation_squared_relu__prompt_kernel_g2loop:
    s_cmp_eq_u32 s72, s79
    s_cbranch_scc1 gated_mix__spectral_fnet__dense_activation_squared_relu__prompt_kernel_g2evt
gated_mix__spectral_fnet__dense_activation_squared_relu__prompt_kernel_g2back:
    s_waitcnt lgkmcnt(0)
    v_mfma_f32_16x16x32_bf16 v[128:131], v[32:35], v[16:19], v[128:131]
    ds_read_b128 v[64:67], v241 offset:0
    v_mfma_f32_16x16x32_bf16 v[132:135], v[32:35], v[20:23], v[132:135]
    ds_read_b64_tr_b16 v[80:81], v242 offset:8192
    v_mfma_f32_16x16x32_bf16 v[136:139], v[32:35], v[24:27], v[136:139]
    ds_read_b64_tr_b16 v[82:83], v242 offset:9216
    v_mfma_f32_16x16x32_bf16 v[140:143], v[32:35], v[28:31], v[140:143]
    ds_read_b128 v[68:71], v241 offset:256
    v_mfma_f32_16x16x32_bf16 v[144:147], v[36:39], v[16:19], v[144:147]
    ds_read_b128 v[72:75], v241 offset:512
    v_mfma_f32_16x16x32_bf16 v[148:151], v[36:39], v[20:23], v[148:151]
    ds_read_b128 v[76:79], v241 offset:768
    v_mfma_f32_16x16x32_bf16 v[152:155], v[36:39], v[24:27], v[152:155]
    ds_read_b64_tr_b16 v[84:85], v243 offset:8192
    v_mfma_f32_16x16x32_bf16 v[156:159], v[36:39], v[28:31], v[156:159]
    ds_read_b64_tr_b16 v[86:87], v243 offset:9216
    v_mfma_f32_16x16x32_bf16 v[160:163], v[40:43], v[16:19], v[160:163]
    ds_read_b64_tr_b16 v[88:89], v244 offset:8192
    v_mfma_f32_16x16x32_bf16 v[164:167], v[40:43], v[20:23], v[164:167]
    ds_read_b64_tr_b16 v[90:91], v244 offset:9216
    v_mfma_f32_16x16x32_bf16 v[168:171], v[40:43], v[24:27], v[168:171]
    ds_read_b64_tr_b16 v[92:93], v245 offset:8192
    v_mfma_f32_16x16x32_bf16 v[172:175], v[40:43], v[28:31], v[172:175]
    ds_read_b64_tr_b16 v[94:95], v245 offset:9216
    v_mfma_f32_16x16x32_bf16 v[176:179], v[44:47], v[16:19], v[176:179]
    s_add_u32 s64, s64, 16384
    s_cmp_eq_u32 s64, 81920
    s_cselect_b32 s70, s67, s66
    s_cselect_b32 s64, 0, s64
    v_mfma_f32_16x16x32_bf16 v[180:183], v[44:47], v[20:23], v[180:183]
    s_add_u32 s65, s65, 16384
    s_cmp_eq_u32 s65, 65536
    s_cselect_b32 s71, s69, s68
    s_cselect_b32 s65, 0, s65
    v_mfma_f32_16x16x32_bf16 v[184:187], v[44:47], v[24:27], v[184:187]
    v_add_u32 v240, s70, v240
    v_add_u32 v241, s70, v241
    v_add_u32 v242, s71, v242
    v_add_u32 v243, s71, v243
    v_add_u32 v244, s71, v244
    v_add_u32 v245, s71, v245
    v_mfma_f32_16x16x32_bf16 v[188:191], v[44:47], v[28:31], v[188:191]
    s_waitcnt lgkmcnt(0)
    s_barrier
    v_mfma_f32_16x16x32_bf16 v[128:131], v[80:83], v[64:67], v[128:131]
    ds_read_b128 v[16:19], v240 offset:0
    v_mfma_f32_16x16x32_bf16 v[132:135], v[80:83], v[68:71], v[132:135]
    ds_read_b64_tr_b16 v[32:33], v242 offset:0
    v_mfma_f32_16x16x32_bf16 v[136:139], v[80:83], v[72:75], v[136:139]
    ds_read_b64_tr_b16 v[34:35], v242 offset:1024
    v_mfma_f32_16x16x32_bf16 v[140:143], v[80:83], v[76:79], v[140:143]
    ds_read_b128 v[20:23], v240 offset:256
    v_mfma_f32_16x16x32_bf16 v[144:147], v[84:87], v[64:67], v[144:147]
    ds_read_b128 v[24:27], v240 offset:512
    v_mfma_f32_16x16x32_bf16 v[148:151], v[84:87], v[68:71], v[148:151]
    ds_read_b128 v[28:31], v240 offset:768
    v_mfma_f32_16x16x32_bf16 v[152:155], v[84:87], v[72:75], v[152:155]
    ds_read_b64_tr_b16 v[36:37], v243 offset:0
    v_mfma_f32_16x16x32_bf16 v[156:159], v[84:87], v[76:79], v[156:159]
    ds_read_b64_tr_b16 v[38:39], v243 offset:1024
    v_mfma_f32_16x16x32_bf16 v[160:163], v[88:91], v[64:67], v[160:163]
    ds_read_b64_tr_b16 v[40:41], v244 offset:0
    v_mfma_f32_16x16x32_bf16 v[164:167], v[88:91], v[68:71], v[164:167]
    ds_read_b64_tr_b16 v[42:43], v244 offset:1024
    v_mfma_f32_16x16x32_bf16 v[168:171], v[88:91], v[72:75], v[168:171]
    ds_read_b64_tr_b16 v[44:45], v245 offset:0
    v_mfma_f32_16x16x32_bf16 v[172:175], v[88:91], v[76:79], v[172:175]
    ds_read_b64_tr_b16 v[46:47], v245 offset:1024
    v_mfma_f32_16x16x32_bf16 v[176:179], v[92:95], v[64:67], v[176:179]
    v_mfma_f32_16x16x32_bf16 v[180:183], v[92:95], v[68:71], v[180:183]
    v_mfma_f32_16x16x32_bf16 v[184:187], v[92:95], v[72:75], v[184:187]
    v_mfma_f32_16x16x32_bf16 v[188:191], v[92:95], v[76:79], v[188:191]
    s_sub_u32 s72, s72, 1
    s_cmp_lg_u32 s72, 0
    s_cbranch_scc1 gated_mix__spectral_fnet__dense_activation_squared_relu__prompt_kernel_g2loop
    s_waitcnt lgkmcnt(0)
    v_mfma_f32_16x16x32_bf16 v[128:131], v[32:35], v[16:19], v[128:131]
    ds_read_b128 v[64:67], v241 offset:0
    v_mfma_f32_16x16x32_bf16 v[132:135], v[32:35], v[20:23], v[132:135]
    ds_read_b64_tr_b16 v[80:81], v242 offset:8192
    v_mfma_f32_16x16x32_bf16 v[136:139], v[32:35], v[24:27], v[136:139]
    ds_read_b64_tr_b16 v[82:83], v242 offset:9216
    v_mfma_f32_16x16x32_bf16 v[140:143], v[32:35], v[28:31], v[140:143]
    ds_read_b128 v[68:71], v241 offset:256
    v_mfma_f32_16x16x32_bf16 v[144:147], v[36:39], v[16:19], v[144:147]
    ds_read_b128 v[72:75], v241 offset:512
    v_mfma_f32_16x16x32_bf16 v[148:151], v[36:39], v[20:23], v[148:151]
    ds_read_b128 v[76:79], v241 offset:768
    v_mfma_f32_16x16x32_bf16 v[152:155], v[36:39], v[24:27], v[152:155]
    ds_read_b64_tr_b16 v[84:85], v243 offset:8192
    v_mfma_f32_16x16x32_bf16 v[156:159], v[36:39], v[28:31], v[156:159]
    ds_read_b64_tr_b16 v[86:87], v243 offset:9216
    v_mfma_f32_16x16x32_bf16 v[160:163], v[40:43], v[16:19], v[160:163]
    ds_read_b64_tr_b16 v[88:89], v244 offset:8192
    v_mfma_f32_16x16x32_bf16 v[164:167], v[40:43], v[20:23], v[164:167]
    ds_read_b64_tr_b16 v[90:91], v244 offset:9216
    v_mfma_f32_16x16x32_bf16 v[168:171], v[40:43], v[24:27], v[168:171]
    ds_read_b64_tr_b16 v[92:93], v245 offset:8192
    v_mfma_f32_16x16x32_bf16 v[172:175], v[40:43], v[28:31], v[172:175]
    ds_read_b64_tr_b16 v[94:95], v245 offset:9216
    v_mfma_f32_16x16x32_bf16 v[176:179], v[44:47], v[16:19], v[176:179]
    s_add_u32 s64, s64, 16384
    s_cmp_eq_u32 s64, 81920
    s_cselect_b32 s70, s67, s66
    s_cselect_b32 s64, 0, s64
    v_mfma_f32_16x16x32_bf16 v[180:183], v[44:47], v[20:23], v[180:183]
    s_add_u32 s65, s65, 16384
    s_cmp_eq_u32 s65, 65536
    s_cselect_b32 s71, s69, s68
    s_cselect_b32 s65, 0, s65
    v_mfma_f32_16x16x32_bf16 v[184:187], v[44:47], v[24:27], v[184:187]
    v_add_u32 v240, s70, v240
    v_add_u32 v241, s70, v241
    v_add_u32 v242, s71, v242
    v_add_u32 v243, s71, v243
    v_add_u32 v244, s71, v244
    v_add_u32 v245, s71, v245
    v_mfma_f32_16x16x32_bf16 v[188:191], v[44:47], v[28:31], v[188:191]
    s_waitcnt lgkmcnt(0)
    v_mfma_f32_16x16x32_bf16 v[128:131], v[80:83], v[64:67], v[128:131]
    v_mfma_f32_16x16x32_bf16 v[132:135], v[80:83], v[68:71], v[132:135]
    v_mfma_f32_16x16x32_bf16 v[136:139], v[80:83], v[72:75], v[136:139]
    v_mfma_f32_16x16x32_bf16 v[140:143], v[80:83], v[76:79], v[140:143]
    v_mfma_f32_16x16x32_bf16 v[144:147], v[84:87], v[64:67], v[144:147]
    v_mfma_f32_16x16x32_bf16 v[148:151], v[84:87], v[68:71], v[148:151]
    v_mfma_f32_16x16x32_bf16 v[152:155], v[84:87], v[72:75], v[152:155]
    v_mfma_f32_16x16x32_bf16 v[156:159], v[84:87], v[76:79], v[156:159]
    v_mfma_f32_16x16x32_bf16 v[160:163], v[88:91], v[64:67], v[160:163]
    v_mfma_f32_16x16x32_bf16 v[164:167], v[88:91], v[68:71], v[164:167]
    v_mfma_f32_16x16x32_bf16 v[168:171], v[88:91], v[72:75], v[168:171]
    v_mfma_f32_16x16x32_bf16 v[172:175], v[88:91], v[76:79], v[172:175]
    v_mfma_f32_16x16x32_bf16 v[176:179], v[92:95], v[64:67], v[176:179]
    v_mfma_f32_16x16x32_bf16 v[180:183], v[92:95], v[68:71], v[180:183]
    v_mfma_f32_16x16x32_bf16 v[184:187], v[92:95], v[72:75], v[184:187]
    v_mfma_f32_16x16x32_bf16 v[188:191], v[92:95], v[76:79], v[188:191]
    s_nop 7
    s_xor_b32 s60, s5, 2
    s_lshl_b32 s60, s60, 14
    s_lshl_b32 s61, s4, 12
    s_add_u32 s60, s60, s61
    s_add_u32 s60, s60, 16777216
    v_lshlrev_b32 v8, 4, v1
    s_cmp_eq_u32 s74, 0
    s_cbranch_scc0 gated_mix__spectral_fnet__dense_activation_squared_relu__prompt_kernel_pk1
    v_cvt_pk_bf16_f32 v96, v160, v161
    v_cvt_pk_bf16_f32 v97, v162, v163
    v_cvt_pk_bf16_f32 v98, v164, v165
    v_cvt_pk_bf16_f32 v99, v166, v167
    v_cvt_pk_bf16_f32 v100, v168, v169
    v_cvt_pk_bf16_f32 v101, v170, v171
    v_cvt_pk_bf16_f32 v102, v172, v173
    v_cvt_pk_bf16_f32 v103, v174, v175
    v_cvt_pk_bf16_f32 v104, v176, v177
    v_cvt_pk_bf16_f32 v105, v178, v179
    v_cvt_pk_bf16_f32 v106, v180, v181
    v_cvt_pk_bf16_f32 v107, v182, v183
    v_cvt_pk_bf16_f32 v108, v184, v185
    v_cvt_pk_bf16_f32 v109, v186, v187
    v_cvt_pk_bf16_f32 v110, v188, v189
    v_cvt_pk_bf16_f32 v111, v190, v191
    s_branch gated_mix__spectral_fnet__dense_activation_squared_relu__prompt_kernel_pk2
gated_mix__spectral_fnet__dense_activation_squared_relu__prompt_kernel_pk1:
    v_cvt_pk_bf16_f32 v96, v128, v129
    v_cvt_pk_bf16_f32 v97, v130, v131
    v_cvt_pk_bf16_f32 v98, v132, v133
    v_cvt_pk_bf16_f32 v99, v134, v135
    v_cvt_pk_bf16_f32 v100, v136, v137
    v_cvt_pk_bf16_f32 v101, v138, v139
    v_cvt_pk_bf16_f32 v102, v140, v141
    v_cvt_pk_bf16_f32 v103, v142, v143
    v_cvt_pk_bf16_f32 v104, v144, v145
    v_cvt_pk_bf16_f32 v105, v146, v147
    v_cvt_pk_bf16_f32 v106, v148, v149
    v_cvt_pk_bf16_f32 v107, v150, v151
    v_cvt_pk_bf16_f32 v108, v152, v153
    v_cvt_pk_bf16_f32 v109, v154, v155
    v_cvt_pk_bf16_f32 v110, v156, v157
    v_cvt_pk_bf16_f32 v111, v158, v159
gated_mix__spectral_fnet__dense_activation_squared_relu__prompt_kernel_pk2:
    s_cmp_eq_u32 s54, 0
    s_cbranch_scc0 gated_mix__spectral_fnet__dense_activation_squared_relu__prompt_kernel_exs
    buffer_store_dwordx4 v[96:99], v8, s[20:23], s60 offen offset:0
    buffer_store_dwordx4 v[100:103], v8, s[20:23], s60 offen offset:1024
    buffer_store_dwordx4 v[104:107], v8, s[20:23], s60 offen offset:2048
    buffer_store_dwordx4 v[108:111], v8, s[20:23], s60 offen offset:3072
    s_branch gated_mix__spectral_fnet__dense_activation_squared_relu__prompt_kernel_exdone
gated_mix__spectral_fnet__dense_activation_squared_relu__prompt_kernel_exs:
    buffer_store_dwordx4 v[96:99], v8, s[20:23], s60 offen offset:0 sc1
    buffer_store_dwordx4 v[100:103], v8, s[20:23], s60 offen offset:1024 sc1
    buffer_store_dwordx4 v[104:107], v8, s[20:23], s60 offen offset:2048 sc1
    buffer_store_dwordx4 v[108:111], v8, s[20:23], s60 offen offset:3072 sc1
gated_mix__spectral_fnet__dense_activation_squared_relu__prompt_kernel_exdone:
    v_lshrrev_b32 v7, 4, v1
    v_bfe_u32 v15, v1, 2, 2
    v_lshl_add_u32 v15, v7, 2, v15
    s_lshl_b32 s61, s59, 5
    v_add_u32 v15, s61, v15
    v_lshlrev_b32 v15, 8, v15
    v_and_b32 v3, 3, v1
    v_lshlrev_b32 v3, 3, v3
    s_lshl_b32 s61, s58, 7
    s_add_u32 s61, s61, 147456
    v_add3_u32 v15, v15, v3, s61
    ds_read_b64_tr_b16 v[16:17], v15 offset:0
    ds_read_b64_tr_b16 v[18:19], v15 offset:32
    ds_read_b64_tr_b16 v[20:21], v15 offset:64
    ds_read_b64_tr_b16 v[22:23], v15 offset:96
    ds_read_b64_tr_b16 v[24:25], v15 offset:4096
    ds_read_b64_tr_b16 v[26:27], v15 offset:4128
    ds_read_b64_tr_b16 v[28:29], v15 offset:4160
    ds_read_b64_tr_b16 v[30:31], v15 offset:4192
    v_sub_f32 v84, 1.0, v250
    v_mul_f32 v250, 0.5, v250
    v_sub_f32 v85, 1.0, v251
    v_mul_f32 v251, 0.5, v251
    v_sub_f32 v86, 1.0, v252
    v_mul_f32 v252, 0.5, v252
    v_sub_f32 v87, 1.0, v253
    v_mul_f32 v253, 0.5, v253
    v_lshlrev_b32 v9, 11, v254
    s_lshl_b32 s61, s75, 8
    s_lshl_b32 s62, s59, 7
    s_add_u32 s61, s61, s62
    s_lshl_b32 s62, s74, 6
    s_add_u32 s61, s61, s62
    v_and_b32 v10, 1, v7
    v_lshlrev_b32 v10, 5, v10
    v_lshrrev_b32 v11, 1, v7
    v_lshlrev_b32 v11, 4, v11
    v_add3_u32 v10, v10, v11, s61
    v_add_u32 v9, v9, v10
    s_cmp_eq_u32 s74, 0
    s_cbranch_scc0 gated_mix__spectral_fnet__dense_activation_squared_relu__prompt_kernel_kp1
    v_mov_b32 v192, v128
    v_mov_b32 v193, v129
    v_mov_b32 v194, v130
    v_mov_b32 v195, v131
    v_mov_b32 v196, v132
    v_mov_b32 v197, v133
    v_mov_b32 v198, v134
    v_mov_b32 v199, v135
    v_mov_b32 v200, v136
    v_mov_b32 v201, v137
    v_mov_b32 v202, v138
    v_mov_b32 v203, v139
    v_mov_b32 v204, v140
    v_mov_b32 v205, v141
    v_mov_b32 v206, v142
    v_mov_b32 v207, v143
    v_mov_b32 v208, v144
    v_mov_b32 v209, v145
    v_mov_b32 v210, v146
    v_mov_b32 v211, v147
    v_mov_b32 v212, v148
    v_mov_b32 v213, v149
    v_mov_b32 v214, v150
    v_mov_b32 v215, v151
    v_mov_b32 v216, v152
    v_mov_b32 v217, v153
    v_mov_b32 v218, v154
    v_mov_b32 v219, v155
    v_mov_b32 v220, v156
    v_mov_b32 v221, v157
    v_mov_b32 v222, v158
    v_mov_b32 v223, v159
    s_branch gated_mix__spectral_fnet__dense_activation_squared_relu__prompt_kernel_kp2
gated_mix__spectral_fnet__dense_activation_squared_relu__prompt_kernel_kp1:
    v_mov_b32 v192, v160
    v_mov_b32 v193, v161
    v_mov_b32 v194, v162
    v_mov_b32 v195, v163
    v_mov_b32 v196, v164
    v_mov_b32 v197, v165
    v_mov_b32 v198, v166
    v_mov_b32 v199, v167
    v_mov_b32 v200, v168
    v_mov_b32 v201, v169
    v_mov_b32 v202, v170
    v_mov_b32 v203, v171
    v_mov_b32 v204, v172
    v_mov_b32 v205, v173
    v_mov_b32 v206, v174
    v_mov_b32 v207, v175
    v_mov_b32 v208, v176
    v_mov_b32 v209, v177
    v_mov_b32 v210, v178
    v_mov_b32 v211, v179
    v_mov_b32 v212, v180
    v_mov_b32 v213, v181
    v_mov_b32 v214, v182
    v_mov_b32 v215, v183
    v_mov_b32 v216, v184
    v_mov_b32 v217, v185
    v_mov_b32 v218, v186
    v_mov_b32 v219, v187
    v_mov_b32 v220, v188
    v_mov_b32 v221, v189
    v_mov_b32 v222, v190
    v_mov_b32 v223, v191
gated_mix__spectral_fnet__dense_activation_squared_relu__prompt_kernel_kp2:
    s_waitcnt lgkmcnt(0)
    v_lshlrev_b32 v32, 16, v16
    v_and_b32 v33, 0xffff0000, v16
    v_lshlrev_b32 v34, 16, v17
    v_and_b32 v35, 0xffff0000, v17
    v_mul_f32 v192, v192, v84
    v_mul_f32 v193, v193, v84
    v_mul_f32 v194, v194, v84
    v_mul_f32 v195, v195, v84
    v_fma_f32 v192, v32, v250, v192
    v_fma_f32 v193, v33, v250, v193
    v_fma_f32 v194, v34, v250, v194
    v_fma_f32 v195, v35, v250, v195
    v_lshlrev_b32 v32, 16, v24
    v_and_b32 v33, 0xffff0000, v24
    v_lshlrev_b32 v34, 16, v25
    v_and_b32 v35, 0xffff0000, v25
    v_mul_f32 v208, v208, v84
    v_mul_f32 v209, v209, v84
    v_mul_f32 v210, v210, v84
    v_mul_f32 v211, v211, v84
    v_fma_f32 v208, v32, v250, v208
    v_fma_f32 v209, v33, v250, v209
    v_fma_f32 v210, v34, v250, v210
    v_fma_f32 v211, v35, v250, v211
    v_lshlrev_b32 v32, 16, v18
    v_and_b32 v33, 0xffff0000, v18
    v_lshlrev_b32 v34, 16, v19
    v_and_b32 v35, 0xffff0000, v19
    v_mul_f32 v196, v196, v85
    v_mul_f32 v197, v197, v85
    v_mul_f32 v198, v198, v85
    v_mul_f32 v199, v199, v85
    v_fma_f32 v196, v32, v251, v196
    v_fma_f32 v197, v33, v251, v197
    v_fma_f32 v198, v34, v251, v198
    v_fma_f32 v199, v35, v251, v199
    v_lshlrev_b32 v32, 16, v26
    v_and_b32 v33, 0xffff0000, v26
    v_lshlrev_b32 v34, 16, v27
    v_and_b32 v35, 0xffff0000, v27
    v_mul_f32 v212, v212, v85
    v_mul_f32 v213, v213, v85
    v_mul_f32 v214, v214, v85
    v_mul_f32 v215, v215, v85
    v_fma_f32 v212, v32, v251, v212
    v_fma_f32 v213, v33, v251, v213
    v_fma_f32 v214, v34, v251, v214
    v_fma_f32 v215, v35, v251, v215
    v_lshlrev_b32 v32, 16, v20
    v_and_b32 v33, 0xffff0000, v20
    v_lshlrev_b32 v34, 16, v21
    v_and_b32 v35, 0xffff0000, v21
    v_mul_f32 v200, v200, v86
    v_mul_f32 v201, v201, v86
    v_mul_f32 v202, v202, v86
    v_mul_f32 v203, v203, v86
    v_fma_f32 v200, v32, v252, v200
    v_fma_f32 v201, v33, v252, v201
    v_fma_f32 v202, v34, v252, v202
    v_fma_f32 v203, v35, v252, v203
    v_lshlrev_b32 v32, 16, v28
    v_and_b32 v33, 0xffff0000, v28
    v_lshlrev_b32 v34, 16, v29
    v_and_b32 v35, 0xffff0000, v29
    v_mul_f32 v216, v216, v86
    v_mul_f32 v217, v217, v86
    v_mul_f32 v218, v218, v86
    v_mul_f32 v219, v219, v86
    v_fma_f32 v216, v32, v252, v216
    v_fma_f32 v217, v33, v252, v217
    v_fma_f32 v218, v34, v252, v218
    v_fma_f32 v219, v35, v252, v219
    v_lshlrev_b32 v32, 16, v22
    v_and_b32 v33, 0xffff0000, v22
    v_lshlrev_b32 v34, 16, v23
    v_and_b32 v35, 0xffff0000, v23
    v_mul_f32 v204, v204, v87
    v_mul_f32 v205, v205, v87
    v_mul_f32 v206, v206, v87
    v_mul_f32 v207, v207, v87
    v_fma_f32 v204, v32, v253, v204
    v_fma_f32 v205, v33, v253, v205
    v_fma_f32 v206, v34, v253, v206
    v_fma_f32 v207, v35, v253, v207
    v_lshlrev_b32 v32, 16, v30
    v_and_b32 v33, 0xffff0000, v30
    v_lshlrev_b32 v34, 16, v31
    v_and_b32 v35, 0xffff0000, v31
    v_mul_f32 v220, v220, v87
    v_mul_f32 v221, v221, v87
    v_mul_f32 v222, v222, v87
    v_mul_f32 v223, v223, v87
    v_fma_f32 v220, v32, v253, v220
    v_fma_f32 v221, v33, v253, v221
    v_fma_f32 v222, v34, v253, v222
    v_fma_f32 v223, v35, v253, v223
    s_waitcnt vmcnt(0)
    s_barrier
    s_barrier
    s_lshl_b32 s60, s5, 14
    s_lshl_b32 s61, s4, 12
    s_add_u32 s60, s60, s61
    s_add_u32 s60, s60, 16777216
    buffer_load_dwordx4 v[112:115], v8, s[20:23], s60 offen offset:0 sc1
    buffer_load_dwordx4 v[116:119], v8, s[20:23], s60 offen offset:1024 sc1
    buffer_load_dwordx4 v[120:123], v8, s[20:23], s60 offen offset:2048 sc1
    buffer_load_dwordx4 v[124:127], v8, s[20:23], s60 offen offset:3072 sc1
    s_waitcnt vmcnt(0)
    v_lshlrev_b32 v32, 16, v112
    v_and_b32 v33, 0xffff0000, v112
    v_lshlrev_b32 v34, 16, v113
    v_and_b32 v35, 0xffff0000, v113
    v_fma_f32 v192, v32, v84, v192
    v_fma_f32 v193, v33, v84, v193
    v_fma_f32 v194, v34, v84, v194
    v_fma_f32 v195, v35, v84, v195
    v_lshlrev_b32 v32, 16, v120
    v_and_b32 v33, 0xffff0000, v120
    v_lshlrev_b32 v34, 16, v121
    v_and_b32 v35, 0xffff0000, v121
    v_fma_f32 v208, v32, v84, v208
    v_fma_f32 v209, v33, v84, v209
    v_fma_f32 v210, v34, v84, v210
    v_fma_f32 v211, v35, v84, v211
    v_cvt_pk_bf16_f32 v40, v192, v193
    v_cvt_pk_bf16_f32 v41, v194, v195
    v_cvt_pk_bf16_f32 v42, v208, v209
    v_cvt_pk_bf16_f32 v43, v210, v211
    s_nop 1
    v_permlane16_swap_b32 v40, v42
    v_permlane16_swap_b32 v41, v43
    s_mov_b32 s60, 0
    buffer_store_dwordx4 v[40:43], v9, s[24:27], s60 offen nt
    v_lshlrev_b32 v32, 16, v114
    v_and_b32 v33, 0xffff0000, v114
    v_lshlrev_b32 v34, 16, v115
    v_and_b32 v35, 0xffff0000, v115
    v_fma_f32 v196, v32, v85, v196
    v_fma_f32 v197, v33, v85, v197
    v_fma_f32 v198, v34, v85, v198
    v_fma_f32 v199, v35, v85, v199
    v_lshlrev_b32 v32, 16, v122
    v_and_b32 v33, 0xffff0000, v122
    v_lshlrev_b32 v34, 16, v123
    v_and_b32 v35, 0xffff0000, v123
    v_fma_f32 v212, v32, v85, v212
    v_fma_f32 v213, v33, v85, v213
    v_fma_f32 v214, v34, v85, v214
    v_fma_f32 v215, v35, v85, v215
    v_cvt_pk_bf16_f32 v44, v196, v197
    v_cvt_pk_bf16_f32 v45, v198, v199
    v_cvt_pk_bf16_f32 v46, v212, v213
    v_cvt_pk_bf16_f32 v47, v214, v215
    s_nop 1
    v_permlane16_swap_b32 v44, v46
    v_permlane16_swap_b32 v45, v47
    s_mov_b32 s60, 32768
    buffer_store_dwordx4 v[44:47], v9, s[24:27], s60 offen nt
    v_lshlrev_b32 v32, 16, v116
    v_and_b32 v33, 0xffff0000, v116
    v_lshlrev_b32 v34, 16, v117
    v_and_b32 v35, 0xffff0000, v117
    v_fma_f32 v200, v32, v86, v200
    v_fma_f32 v201, v33, v86, v201
    v_fma_f32 v202, v34, v86, v202
    v_fma_f32 v203, v35, v86, v203
    v_lshlrev_b32 v32, 16, v124
    v_and_b32 v33, 0xffff0000, v124
    v_lshlrev_b32 v34, 16, v125
    v_and_b32 v35, 0xffff0000, v125
    v_fma_f32 v216, v32, v86, v216
    v_fma_f32 v217, v33, v86, v217
    v_fma_f32 v218, v34, v86, v218
    v_fma_f32 v219, v35, v86, v219
    v_cvt_pk_bf16_f32 v48, v200, v201
    v_cvt_pk_bf16_f32 v49, v202, v203
    v_cvt_pk_bf16_f32 v50, v216, v217
    v_cvt_pk_bf16_f32 v51, v218, v219
    s_nop 1
    v_permlane16_swap_b32 v48, v50
    v_permlane16_swap_b32 v49, v51
    s_mov_b32 s60, 65536
    buffer_store_dwordx4 v[48:51], v9, s[24:27], s60 offen nt
    v_lshlrev_b32 v32, 16, v118
    v_and_b32 v33, 0xffff0000, v118
    v_lshlrev_b32 v34, 16, v119
    v_and_b32 v35, 0xffff0000, v119
    v_fma_f32 v204, v32, v87, v204
    v_fma_f32 v205, v33, v87, v205
    v_fma_f32 v206, v34, v87, v206
    v_fma_f32 v207, v35, v87, v207
    v_lshlrev_b32 v32, 16, v126
    v_and_b32 v33, 0xffff0000, v126
    v_lshlrev_b32 v34, 16, v127
    v_and_b32 v35, 0xffff0000, v127
    v_fma_f32 v220, v32, v87, v220
    v_fma_f32 v221, v33, v87, v221
    v_fma_f32 v222, v34, v87, v222
    v_fma_f32 v223, v35, v87, v223
    v_cvt_pk_bf16_f32 v52, v204, v205
    v_cvt_pk_bf16_f32 v53, v206, v207
    v_cvt_pk_bf16_f32 v54, v220, v221
    v_cvt_pk_bf16_f32 v55, v222, v223
    s_nop 1
    v_permlane16_swap_b32 v52, v54
    v_permlane16_swap_b32 v53, v55
    s_mov_b32 s60, 98304
    buffer_store_dwordx4 v[52:55], v9, s[24:27], s60 offen nt
    s_endpgm
gated_mix__spectral_fnet__dense_activation_squared_relu__prompt_kernel_g1evt:
    s_waitcnt vmcnt(0)
    s_mov_b32 s79, 99
    s_branch gated_mix__spectral_fnet__dense_activation_squared_relu__prompt_kernel_g1back
gated_mix__spectral_fnet__dense_activation_squared_relu__prompt_kernel_g2evt:
    s_waitcnt vmcnt(0)
    s_mov_b32 s79, 99
    s_branch gated_mix__spectral_fnet__dense_activation_squared_relu__prompt_kernel_g2back
gated_mix__spectral_fnet__dense_activation_squared_relu__prompt_kernel_aux:
    s_sub_u32 s55, s3, 4
    v_mov_b32 v236, 0
    v_mov_b32 v237, 0
    v_lshrrev_b32 v248, 3, v1
    v_and_b32 v249, 7, v1
    v_xor_b32 v249, v249, v248
    v_lshlrev_b32 v249, 4, v249
    v_lshlrev_b32 v248, 11, v248
    v_add_u32 v248, v248, v249
    v_mov_b32 v224, v248
    v_add_u32 v225, 15360, v248
    v_add_u32 v226, 30720, v248
    v_add_u32 v227, 46080, v248
    v_add_u32 v248, 0, v1
    v_mul_u32_u24 v249, 2341, v248
    v_lshrrev_b32 v249, 16, v249
    v_mul_u32_u24 v250, 28, v249
    v_sub_u32 v250, v248, v250
    v_bfe_u32 v248, v249, 3, 1
    v_lshlrev_b32 v248, 1, v248
    v_xor_b32 v250, v250, v248
    v_lshlrev_b32 v250, 4, v250
    v_mul_u32_u24 v249, 7168, v249
    v_add_u32 v249, v249, v250
    v_mov_b32 v228, v249
    v_add_u32 v248, 64, v1
    v_mul_u32_u24 v249, 2341, v248
    v_lshrrev_b32 v249, 16, v249
    v_mul_u32_u24 v250, 28, v249
    v_sub_u32 v250, v248, v250
    v_bfe_u32 v248, v249, 3, 1
    v_lshlrev_b32 v248, 1, v248
    v_xor_b32 v250, v250, v248
    v_lshlrev_b32 v250, 4, v250
    v_mul_u32_u24 v249, 7168, v249
    v_add_u32 v249, v249, v250
    v_subrev_u32 v229, 1024, v249
    v_add_u32 v248, 128, v1
    v_mul_u32_u24 v249, 2341, v248
    v_lshrrev_b32 v249, 16, v249
    v_mul_u32_u24 v250, 28, v249
    v_sub_u32 v250, v248, v250
    v_bfe_u32 v248, v249, 3, 1
    v_lshlrev_b32 v248, 1, v248
    v_xor_b32 v250, v250, v248
    v_lshlrev_b32 v250, 4, v250
    v_mul_u32_u24 v249, 7168, v249
    v_add_u32 v249, v249, v250
    v_subrev_u32 v230, 2048, v249
    v_add_u32 v248, 192, v1
    v_mul_u32_u24 v249, 2341, v248
    v_lshrrev_b32 v249, 16, v249
    v_mul_u32_u24 v250, 28, v249
    v_sub_u32 v250, v248, v250
    v_bfe_u32 v248, v249, 3, 1
    v_lshlrev_b32 v248, 1, v248
    v_xor_b32 v250, v250, v248
    v_lshlrev_b32 v250, 4, v250
    v_mul_u32_u24 v249, 7168, v249
    v_add_u32 v249, v249, v250
    v_subrev_u32 v231, 3072, v249
    v_add_u32 v248, 256, v1
    v_mul_u32_u24 v249, 2341, v248
    v_lshrrev_b32 v249, 16, v249
    v_mul_u32_u24 v250, 28, v249
    v_sub_u32 v250, v248, v250
    v_bfe_u32 v248, v249, 3, 1
    v_lshlrev_b32 v248, 1, v248
    v_xor_b32 v250, v250, v248
    v_lshlrev_b32 v250, 4, v250
    v_mul_u32_u24 v249, 7168, v249
    v_add_u32 v249, v249, v250
    v_mov_b32 v232, v249
    v_add_u32 v248, 320, v1
    v_mul_u32_u24 v249, 2341, v248
    v_lshrrev_b32 v249, 16, v249
    v_mul_u32_u24 v250, 28, v249
    v_sub_u32 v250, v248, v250
    v_bfe_u32 v248, v249, 3, 1
    v_lshlrev_b32 v248, 1, v248
    v_xor_b32 v250, v250, v248
    v_lshlrev_b32 v250, 4, v250
    v_mul_u32_u24 v249, 7168, v249
    v_add_u32 v249, v249, v250
    v_subrev_u32 v233, 1024, v249
    v_add_u32 v248, 384, v1
    v_mul_u32_u24 v249, 2341, v248
    v_lshrrev_b32 v249, 16, v249
    v_mul_u32_u24 v250, 28, v249
    v_sub_u32 v250, v248, v250
    v_bfe_u32 v248, v249, 3, 1
    v_lshlrev_b32 v248, 1, v248
    v_xor_b32 v250, v250, v248
    v_lshlrev_b32 v250, 4, v250
    v_mul_u32_u24 v249, 7168, v249
    v_add_u32 v249, v249, v250
    v_subrev_u32 v234, 2048, v249
    v_lshlrev_b32 v235, 4, v1
    v_lshrrev_b32 v248, 4, v1
    v_bfe_u32 v249, v1, 1, 3
    v_xor_b32 v249, v249, v248
    v_and_b32 v250, 1, v1
    v_lshlrev_b32 v250, 4, v250
    v_lshlrev_b32 v251, 11, v248
    v_add_u32 v250, v250, v251
    v_xor_b32 v251, 0, v249
    v_lshlrev_b32 v251, 5, v251
    v_add_u32 v251, v251, v250
    v_mov_b32 v220, v251
    v_xor_b32 v251, 0, v249
    v_lshlrev_b32 v251, 5, v251
    v_add_u32 v251, v251, v250
    v_add_u32 v221, 7168, v251
    v_xor_b32 v251, 4, v249
    v_lshlrev_b32 v251, 5, v251
    v_add_u32 v251, v251, v250
    v_add_u32 v222, 14336, v251
    v_xor_b32 v251, 4, v249
    v_lshlrev_b32 v251, 5, v251
    v_add_u32 v251, v251, v250
    v_add_u32 v223, 21504, v251
    s_mul_i32 s64, s6, 2
    s_cmp_ge_u32 s3, 6
    s_cbranch_scc1 gated_mix__spectral_fnet__dense_activation_squared_relu__prompt_kernel_S1
    s_lshl_b32 s62, s56, 18
    s_lshl_b32 s61, s55, 17
    s_add_u32 s62, s62, s61
    s_mul_i32 s63, s57, 448
    s_mul_i32 s61, s55, 229376
    s_add_u32 s63, s63, s61
    s_lshl_b32 s65, s55, 13
    s_mul_i32 s66, s55, 14336
    s_add_u32 s66, s66, 32768
    s_add_u32 s67, s64, 0
    s_and_b32 s67, s67, 15
    s_lshl_b32 s67, s67, 7
    s_add_u32 s67, s67, s62
    s_add_u32 m0, s65, 0
    s_nop 0
    buffer_load_dwordx4 v224, s[8:11], s67 offen offset:0 lds
    buffer_load_dwordx4 v225, s[8:11], s67 offen offset:1024 lds
    buffer_load_dwordx4 v226, s[8:11], s67 offen offset:2048 lds
    buffer_load_dwordx4 v227, s[8:11], s67 offen offset:3072 lds
    s_add_u32 m0, s65, 4096
    s_add_u32 s67, s67, 65536
    buffer_load_dwordx4 v224, s[8:11], s67 offen offset:0 lds
    buffer_load_dwordx4 v225, s[8:11], s67 offen offset:1024 lds
    buffer_load_dwordx4 v226, s[8:11], s67 offen offset:2048 lds
    buffer_load_dwordx4 v227, s[8:11], s67 offen offset:3072 lds
    s_add_u32 s67, s64, 0
    s_and_b32 s67, s67, 15
    s_mul_i32 s67, s67, 458752
    s_add_u32 s67, s67, s63
    s_add_u32 m0, s66, 0
    s_nop 0
    buffer_load_dwordx4 v228, s[12:15], s67 offen offset:0 lds
    buffer_load_dwordx4 v229, s[12:15], s67 offen offset:1024 lds
    buffer_load_dwordx4 v230, s[12:15], s67 offen offset:2048 lds
    buffer_load_dwordx4 v231, s[12:15], s67 offen offset:3072 lds
    s_add_u32 m0, s66, 4096
    s_nop 0
    buffer_load_dwordx4 v232, s[12:15], s67 offen offset:0 lds
    buffer_load_dwordx4 v233, s[12:15], s67 offen offset:1024 lds
    buffer_load_dwordx4 v234, s[12:15], s67 offen offset:2048 lds
    s_add_u32 s67, s67, 114688
    s_add_u32 m0, s66, 7168
    s_nop 0
    buffer_load_dwordx4 v228, s[12:15], s67 offen offset:0 lds
    buffer_load_dwordx4 v229, s[12:15], s67 offen offset:1024 lds
    buffer_load_dwordx4 v230, s[12:15], s67 offen offset:2048 lds
    buffer_load_dwordx4 v231, s[12:15], s67 offen offset:3072 lds
    s_add_u32 m0, s66, 11264
    s_nop 0
    buffer_load_dwordx4 v232, s[12:15], s67 offen offset:0 lds
    buffer_load_dwordx4 v233, s[12:15], s67 offen offset:1024 lds
    buffer_load_dwordx4 v234, s[12:15], s67 offen offset:2048 lds
    s_add_u32 s67, s64, 1
    s_and_b32 s67, s67, 15
    s_lshl_b32 s67, s67, 7
    s_add_u32 s67, s67, s62
    s_add_u32 m0, s65, 16384
    s_nop 0
    buffer_load_dwordx4 v224, s[8:11], s67 offen offset:0 lds
    buffer_load_dwordx4 v225, s[8:11], s67 offen offset:1024 lds
    buffer_load_dwordx4 v226, s[8:11], s67 offen offset:2048 lds
    buffer_load_dwordx4 v227, s[8:11], s67 offen offset:3072 lds
    s_add_u32 m0, s65, 20480
    s_add_u32 s67, s67, 65536
    buffer_load_dwordx4 v224, s[8:11], s67 offen offset:0 lds
    buffer_load_dwordx4 v225, s[8:11], s67 offen offset:1024 lds
    buffer_load_dwordx4 v226, s[8:11], s67 offen offset:2048 lds
    buffer_load_dwordx4 v227, s[8:11], s67 offen offset:3072 lds
    s_add_u32 s67, s64, 1
    s_and_b32 s67, s67, 15
    s_mul_i32 s67, s67, 458752
    s_add_u32 s67, s67, s63
    s_add_u32 m0, s66, 28672
    s_nop 0
    buffer_load_dwordx4 v228, s[12:15], s67 offen offset:0 lds
    buffer_load_dwordx4 v229, s[12:15], s67 offen offset:1024 lds
    buffer_load_dwordx4 v230, s[12:15], s67 offen offset:2048 lds
    buffer_load_dwordx4 v231, s[12:15], s67 offen offset:3072 lds
    s_add_u32 m0, s66, 32768
    s_nop 0
    buffer_load_dwordx4 v232, s[12:15], s67 offen offset:0 lds
    buffer_load_dwordx4 v233, s[12:15], s67 offen offset:1024 lds
    buffer_load_dwordx4 v234, s[12:15], s67 offen offset:2048 lds
    s_add_u32 s67, s67, 114688
    s_add_u32 m0, s66, 35840
    s_nop 0
    buffer_load_dwordx4 v228, s[12:15], s67 offen offset:0 lds
    buffer_load_dwordx4 v229, s[12:15], s67 offen offset:1024 lds
    buffer_load_dwordx4 v230, s[12:15], s67 offen offset:2048 lds
    buffer_load_dwordx4 v231, s[12:15], s67 offen offset:3072 lds
    s_add_u32 m0, s66, 39936
    s_nop 0
    buffer_load_dwordx4 v232, s[12:15], s67 offen offset:0 lds
    buffer_load_dwordx4 v233, s[12:15], s67 offen offset:1024 lds
    buffer_load_dwordx4 v234, s[12:15], s67 offen offset:2048 lds
    s_and_b32 s67, s7, 1
    s_lshl_b32 s69, s6, 5
    s_lshl_b32 s70, s67, 4
    s_add_u32 s69, s69, s70
    s_lshl_b32 s70, s74, 3
    s_add_u32 s70, s69, s70
    v_add_u32 v236, s70, v1
    v_lshlrev_b32 v236, 2, v236
    v_add_u32 v236, 25231360, v236
    s_xor_b32 s70, s5, 2
    s_lshl_b32 s70, s70, 2
    s_add_u32 s70, s70, 25235456
    v_writelane_b32 v236, s70, 8
    s_add_u32 s70, s69, s57
    s_lshl_b32 s70, s70, 2
    s_add_u32 s70, s70, 25231360
    v_writelane_b32 v236, s70, 9
    s_lshl_b32 s70, s5, 2
    s_add_u32 s70, s70, 25235456
    v_writelane_b32 v236, s70, 10
    s_mov_b64 exec, 0x7ff
    buffer_load_dword v237, v236, s[20:23], 0 offen sc1
    s_mov_b64 exec, -1
    v_and_b32 v2, 31, v1
    v_cvt_f32_u32 v2, v2
    v_mul_f32 v2, 0x3d000000, v2
    v_lshrrev_b32 v3, 5, v1
    v_cvt_f32_u32 v3, v3
    v_mul_f32 v3, 4.0, v3
    v_mul_f32 v3, v3, v2
    v_mul_f32 v4, 0x40a00000, v2
    v_fract_f32 v5, v3
    v_cos_f32 v96, v5
    v_sin_f32 v112, v5
    v_add_f32 v3, v3, v2
    v_fract_f32 v5, v3
    v_cos_f32 v97, v5
    v_sin_f32 v113, v5
    v_add_f32 v3, v3, v2
    v_fract_f32 v5, v3
    v_cos_f32 v98, v5
    v_sin_f32 v114, v5
    v_add_f32 v3, v3, v2
    v_fract_f32 v5, v3
    v_cos_f32 v99, v5
    v_sin_f32 v115, v5
    v_add_f32 v3, v3, v4
    v_fract_f32 v5, v3
    v_cos_f32 v100, v5
    v_sin_f32 v116, v5
    v_add_f32 v3, v3, v2
    v_fract_f32 v5, v3
    v_cos_f32 v101, v5
    v_sin_f32 v117, v5
    v_add_f32 v3, v3, v2
    v_fract_f32 v5, v3
    v_cos_f32 v102, v5
    v_sin_f32 v118, v5
    v_add_f32 v3, v3, v2
    v_fract_f32 v5, v3
    v_cos_f32 v103, v5
    v_sin_f32 v119, v5
    v_add_f32 v3, v3, v4
    v_fract_f32 v5, v3
    v_cos_f32 v104, v5
    v_sin_f32 v120, v5
    v_add_f32 v3, v3, v2
    v_fract_f32 v5, v3
    v_cos_f32 v105, v5
    v_sin_f32 v121, v5
    v_add_f32 v3, v3, v2
    v_fract_f32 v5, v3
    v_cos_f32 v106, v5
    v_sin_f32 v122, v5
    v_add_f32 v3, v3, v2
    v_fract_f32 v5, v3
    v_cos_f32 v107, v5
    v_sin_f32 v123, v5
    v_add_f32 v3, v3, v4
    v_fract_f32 v5, v3
    v_cos_f32 v108, v5
    v_sin_f32 v124, v5
    v_add_f32 v3, v3, v2
    v_fract_f32 v5, v3
    v_cos_f32 v109, v5
    v_sin_f32 v125, v5
    v_add_f32 v3, v3, v2
    v_fract_f32 v5, v3
    v_cos_f32 v110, v5
    v_sin_f32 v126, v5
    v_add_f32 v3, v3, v2
    v_fract_f32 v5, v3
    v_cos_f32 v111, v5
    v_sin_f32 v127, v5
    s_nop 0
    v_cvt_pk_bf16_f32 v16, v96, v97
    v_cvt_pk_bf16_f32 v24, v112, v113
    v_cvt_pk_bf16_f32 v17, v98, v99
    v_cvt_pk_bf16_f32 v25, v114, v115
    v_cvt_pk_bf16_f32 v18, v100, v101
    v_cvt_pk_bf16_f32 v26, v116, v117
    v_cvt_pk_bf16_f32 v19, v102, v103
    v_cvt_pk_bf16_f32 v27, v118, v119
    v_cvt_pk_bf16_f32 v20, v104, v105
    v_cvt_pk_bf16_f32 v28, v120, v121
    v_cvt_pk_bf16_f32 v21, v106, v107
    v_cvt_pk_bf16_f32 v29, v122, v123
    v_cvt_pk_bf16_f32 v22, v108, v109
    v_cvt_pk_bf16_f32 v30, v124, v125
    v_cvt_pk_bf16_f32 v23, v110, v111
    v_cvt_pk_bf16_f32 v31, v126, v127
    v_xor_b32 v32, 0x80008000, v24
    v_xor_b32 v33, 0x80008000, v25
    v_xor_b32 v34, 0x80008000, v26
    v_xor_b32 v35, 0x80008000, v27
    v_xor_b32 v36, 0x80008000, v28
    v_xor_b32 v37, 0x80008000, v29
    v_xor_b32 v38, 0x80008000, v30
    v_xor_b32 v39, 0x80008000, v31
    v_and_b32 v2, 31, v1
    v_cvt_f32_u32 v2, v2
    v_mul_f32 v2, 0x3a800000, v2
    v_lshrrev_b32 v3, 5, v1
    v_cvt_f32_u32 v3, v3
    v_mul_f32 v3, 4.0, v3
    v_mul_f32 v3, v3, v2
    v_mul_f32 v4, 0x40a00000, v2
    v_cos_f32 v96, v3
    v_sin_f32 v112, v3
    v_add_f32 v3, v3, v2
    v_cos_f32 v97, v3
    v_sin_f32 v113, v3
    v_add_f32 v3, v3, v2
    v_cos_f32 v98, v3
    v_sin_f32 v114, v3
    v_add_f32 v3, v3, v2
    v_cos_f32 v99, v3
    v_sin_f32 v115, v3
    v_add_f32 v3, v3, v4
    v_cos_f32 v100, v3
    v_sin_f32 v116, v3
    v_add_f32 v3, v3, v2
    v_cos_f32 v101, v3
    v_sin_f32 v117, v3
    v_add_f32 v3, v3, v2
    v_cos_f32 v102, v3
    v_sin_f32 v118, v3
    v_add_f32 v3, v3, v2
    v_cos_f32 v103, v3
    v_sin_f32 v119, v3
    v_add_f32 v3, v3, v4
    v_cos_f32 v104, v3
    v_sin_f32 v120, v3
    v_add_f32 v3, v3, v2
    v_cos_f32 v105, v3
    v_sin_f32 v121, v3
    v_add_f32 v3, v3, v2
    v_cos_f32 v106, v3
    v_sin_f32 v122, v3
    v_add_f32 v3, v3, v2
    v_cos_f32 v107, v3
    v_sin_f32 v123, v3
    v_add_f32 v3, v3, v4
    v_cos_f32 v108, v3
    v_sin_f32 v124, v3
    v_add_f32 v3, v3, v2
    v_cos_f32 v109, v3
    v_sin_f32 v125, v3
    v_add_f32 v3, v3, v2
    v_cos_f32 v110, v3
    v_sin_f32 v126, v3
    v_add_f32 v3, v3, v2
    v_cos_f32 v111, v3
    v_sin_f32 v127, v3
    v_and_b32 v2, 31, v1
    v_lshrrev_b32 v3, 5, v1
    v_lshlrev_b32 v5, 5, v2
    v_lshl_add_u32 v5, v3, 2, v5
    v_cvt_f32_u32 v5, v5
    v_mul_f32 v5, 0x3a000000, v5
    v_mov_b32 v4, 0x3a000000
    v_mov_b32 v7, 0x3b200000
    v_cos_f32 v176, v5
    v_sin_f32 v192, v5
    v_add_f32 v5, v5, v4
    v_cos_f32 v177, v5
    v_sin_f32 v193, v5
    v_add_f32 v5, v5, v4
    v_cos_f32 v178, v5
    v_sin_f32 v194, v5
    v_add_f32 v5, v5, v4
    v_cos_f32 v179, v5
    v_sin_f32 v195, v5
    v_add_f32 v5, v5, v7
    v_cos_f32 v180, v5
    v_sin_f32 v196, v5
    v_add_f32 v5, v5, v4
    v_cos_f32 v181, v5
    v_sin_f32 v197, v5
    v_add_f32 v5, v5, v4
    v_cos_f32 v182, v5
    v_sin_f32 v198, v5
    v_add_f32 v5, v5, v4
    v_cos_f32 v183, v5
    v_sin_f32 v199, v5
    v_add_f32 v5, v5, v7
    v_cos_f32 v184, v5
    v_sin_f32 v200, v5
    v_add_f32 v5, v5, v4
    v_cos_f32 v185, v5
    v_sin_f32 v201, v5
    v_add_f32 v5, v5, v4
    v_cos_f32 v186, v5
    v_sin_f32 v202, v5
    v_add_f32 v5, v5, v4
    v_cos_f32 v187, v5
    v_sin_f32 v203, v5
    v_add_f32 v5, v5, v7
    v_cos_f32 v188, v5
    v_sin_f32 v204, v5
    v_add_f32 v5, v5, v4
    v_cos_f32 v189, v5
    v_sin_f32 v205, v5
    v_add_f32 v5, v5, v4
    v_cos_f32 v190, v5
    v_sin_f32 v206, v5
    v_add_f32 v5, v5, v4
    v_cos_f32 v191, v5
    v_sin_f32 v207, v5
    s_waitcnt vmcnt(23)
    s_barrier
    s_add_u32 s67, s64, 2
    s_and_b32 s67, s67, 15
    s_mul_i32 s67, s67, 458752
    s_add_u32 s67, s67, s63
    s_add_u32 m0, s66, 57344
    s_nop 0
    buffer_load_dwordx4 v228, s[12:15], s67 offen offset:0 lds
    buffer_load_dwordx4 v229, s[12:15], s67 offen offset:1024 lds
    buffer_load_dwordx4 v230, s[12:15], s67 offen offset:2048 lds
    buffer_load_dwordx4 v231, s[12:15], s67 offen offset:3072 lds
    s_add_u32 m0, s66, 61440
    s_nop 0
    buffer_load_dwordx4 v232, s[12:15], s67 offen offset:0 lds
    buffer_load_dwordx4 v233, s[12:15], s67 offen offset:1024 lds
    buffer_load_dwordx4 v234, s[12:15], s67 offen offset:2048 lds
    s_add_u32 s67, s67, 114688
    s_add_u32 m0, s66, 64512
    s_nop 0
    buffer_load_dwordx4 v228, s[12:15], s67 offen offset:0 lds
    buffer_load_dwordx4 v229, s[12:15], s67 offen offset:1024 lds
    buffer_load_dwordx4 v230, s[12:15], s67 offen offset:2048 lds
    buffer_load_dwordx4 v231, s[12:15], s67 offen offset:3072 lds
    s_add_u32 m0, s66, 68608
    s_nop 0
    buffer_load_dwordx4 v232, s[12:15], s67 offen offset:0 lds
    buffer_load_dwordx4 v233, s[12:15], s67 offen offset:1024 lds
    buffer_load_dwordx4 v234, s[12:15], s67 offen offset:2048 lds
    s_add_u32 s67, s64, 3
    s_and_b32 s67, s67, 15
    s_mul_i32 s67, s67, 458752
    s_add_u32 s67, s67, s63
    s_add_u32 m0, s66, 86016
    s_nop 0
    buffer_load_dwordx4 v228, s[12:15], s67 offen offset:0 lds
    buffer_load_dwordx4 v229, s[12:15], s67 offen offset:1024 lds
    buffer_load_dwordx4 v230, s[12:15], s67 offen offset:2048 lds
    buffer_load_dwordx4 v231, s[12:15], s67 offen offset:3072 lds
    s_add_u32 m0, s66, 90112
    s_nop 0
    buffer_load_dwordx4 v232, s[12:15], s67 offen offset:0 lds
    buffer_load_dwordx4 v233, s[12:15], s67 offen offset:1024 lds
    buffer_load_dwordx4 v234, s[12:15], s67 offen offset:2048 lds
    s_add_u32 s67, s67, 114688
    s_add_u32 m0, s66, 93184
    s_nop 0
    buffer_load_dwordx4 v228, s[12:15], s67 offen offset:0 lds
    buffer_load_dwordx4 v229, s[12:15], s67 offen offset:1024 lds
    buffer_load_dwordx4 v230, s[12:15], s67 offen offset:2048 lds
    buffer_load_dwordx4 v231, s[12:15], s67 offen offset:3072 lds
    s_add_u32 m0, s66, 97280
    s_nop 0
    buffer_load_dwordx4 v232, s[12:15], s67 offen offset:0 lds
    buffer_load_dwordx4 v233, s[12:15], s67 offen offset:1024 lds
    buffer_load_dwordx4 v234, s[12:15], s67 offen offset:2048 lds
    s_lshl_b32 s71, s75, 8
    s_lshl_b32 s61, s55, 16
    s_add_u32 s71, s71, s61
    s_mul_i32 s61, s74, 3670016
    s_add_u32 s71, s71, s61
    s_mul_i32 s72, s6, 7
    s_lshr_b32 s72, s72, 1
    s_waitcnt vmcnt(29)
    s_barrier
    s_add_u32 s67, s64, 2
    s_and_b32 s67, s67, 15
    s_lshl_b32 s67, s67, 7
    s_add_u32 s67, s67, s62
    s_add_u32 m0, s65, 0
    s_nop 0
    buffer_load_dwordx4 v224, s[8:11], s67 offen offset:0 lds
    buffer_load_dwordx4 v225, s[8:11], s67 offen offset:1024 lds
    buffer_load_dwordx4 v226, s[8:11], s67 offen offset:2048 lds
    buffer_load_dwordx4 v227, s[8:11], s67 offen offset:3072 lds
    s_add_u32 m0, s65, 4096
    s_add_u32 s67, s67, 65536
    buffer_load_dwordx4 v224, s[8:11], s67 offen offset:0 lds
    buffer_load_dwordx4 v225, s[8:11], s67 offen offset:1024 lds
    buffer_load_dwordx4 v226, s[8:11], s67 offen offset:2048 lds
    buffer_load_dwordx4 v227, s[8:11], s67 offen offset:3072 lds
    s_add_u32 s67, s64, 4
    s_and_b32 s67, s67, 15
    s_mul_i32 s67, s67, 458752
    s_add_u32 s67, s67, s63
    s_add_u32 m0, s66, 0
    s_nop 0
    buffer_load_dwordx4 v228, s[12:15], s67 offen offset:0 lds
    buffer_load_dwordx4 v229, s[12:15], s67 offen offset:1024 lds
    buffer_load_dwordx4 v230, s[12:15], s67 offen offset:2048 lds
    buffer_load_dwordx4 v231, s[12:15], s67 offen offset:3072 lds
    s_add_u32 m0, s66, 4096
    s_nop 0
    buffer_load_dwordx4 v232, s[12:15], s67 offen offset:0 lds
    buffer_load_dwordx4 v233, s[12:15], s67 offen offset:1024 lds
    buffer_load_dwordx4 v234, s[12:15], s67 offen offset:2048 lds
    s_add_u32 s67, s67, 114688
    s_add_u32 m0, s66, 7168
    s_nop 0
    buffer_load_dwordx4 v228, s[12:15], s67 offen offset:0 lds
    buffer_load_dwordx4 v229, s[12:15], s67 offen offset:1024 lds
    buffer_load_dwordx4 v230, s[12:15], s67 offen offset:2048 lds
    buffer_load_dwordx4 v231, s[12:15], s67 offen offset:3072 lds
    s_add_u32 m0, s66, 11264
    s_nop 0
    buffer_load_dwordx4 v232, s[12:15], s67 offen offset:0 lds
    buffer_load_dwordx4 v233, s[12:15], s67 offen offset:1024 lds
    buffer_load_dwordx4 v234, s[12:15], s67 offen offset:2048 lds
    s_waitcnt vmcnt(14)
    s_barrier
    s_add_u32 s67, s64, 3
    s_and_b32 s67, s67, 15
    s_lshl_b32 s67, s67, 7
    s_add_u32 s67, s67, s62
    s_add_u32 m0, s65, 16384
    s_nop 0
    buffer_load_dwordx4 v224, s[8:11], s67 offen offset:0 lds
    buffer_load_dwordx4 v225, s[8:11], s67 offen offset:1024 lds
    buffer_load_dwordx4 v226, s[8:11], s67 offen offset:2048 lds
    buffer_load_dwordx4 v227, s[8:11], s67 offen offset:3072 lds
    s_add_u32 m0, s65, 20480
    s_add_u32 s67, s67, 65536
    buffer_load_dwordx4 v224, s[8:11], s67 offen offset:0 lds
    buffer_load_dwordx4 v225, s[8:11], s67 offen offset:1024 lds
    buffer_load_dwordx4 v226, s[8:11], s67 offen offset:2048 lds
    buffer_load_dwordx4 v227, s[8:11], s67 offen offset:3072 lds
    s_add_u32 s67, s64, 5
    s_and_b32 s67, s67, 15
    s_mul_i32 s67, s67, 458752
    s_add_u32 s67, s67, s63
    s_add_u32 m0, s66, 28672
    s_nop 0
    buffer_load_dwordx4 v228, s[12:15], s67 offen offset:0 lds
    buffer_load_dwordx4 v229, s[12:15], s67 offen offset:1024 lds
    buffer_load_dwordx4 v230, s[12:15], s67 offen offset:2048 lds
    buffer_load_dwordx4 v231, s[12:15], s67 offen offset:3072 lds
    s_add_u32 m0, s66, 32768
    s_nop 0
    buffer_load_dwordx4 v232, s[12:15], s67 offen offset:0 lds
    buffer_load_dwordx4 v233, s[12:15], s67 offen offset:1024 lds
    buffer_load_dwordx4 v234, s[12:15], s67 offen offset:2048 lds
    s_add_u32 s67, s67, 114688
    s_add_u32 m0, s66, 35840
    s_nop 0
    buffer_load_dwordx4 v228, s[12:15], s67 offen offset:0 lds
    buffer_load_dwordx4 v229, s[12:15], s67 offen offset:1024 lds
    buffer_load_dwordx4 v230, s[12:15], s67 offen offset:2048 lds
    buffer_load_dwordx4 v231, s[12:15], s67 offen offset:3072 lds
    s_add_u32 m0, s66, 39936
    s_nop 0
    buffer_load_dwordx4 v232, s[12:15], s67 offen offset:0 lds
    buffer_load_dwordx4 v233, s[12:15], s67 offen offset:1024 lds
    buffer_load_dwordx4 v234, s[12:15], s67 offen offset:2048 lds
    s_waitcnt vmcnt(14)
    v_add_u32 v237, 1, v237
    s_barrier
    s_add_u32 s67, s64, 4
    s_and_b32 s67, s67, 15
    s_lshl_b32 s67, s67, 7
    s_add_u32 s67, s67, s62
    s_add_u32 m0, s65, 0
    s_nop 0
    buffer_load_dwordx4 v224, s[8:11], s67 offen offset:0 lds
    buffer_load_dwordx4 v225, s[8:11], s67 offen offset:1024 lds
    buffer_load_dwordx4 v226, s[8:11], s67 offen offset:2048 lds
    buffer_load_dwordx4 v227, s[8:11], s67 offen offset:3072 lds
    s_add_u32 m0, s65, 4096
    s_add_u32 s67, s67, 65536
    buffer_load_dwordx4 v224, s[8:11], s67 offen offset:0 lds
    buffer_load_dwordx4 v225, s[8:11], s67 offen offset:1024 lds
    buffer_load_dwordx4 v226, s[8:11], s67 offen offset:2048 lds
    buffer_load_dwordx4 v227, s[8:11], s67 offen offset:3072 lds
    s_add_u32 s67, s64, 6
    s_and_b32 s67, s67, 15
    s_mul_i32 s67, s67, 458752
    s_add_u32 s67, s67, s63
    s_add_u32 m0, s66, 57344
    s_nop 0
    buffer_load_dwordx4 v228, s[12:15], s67 offen offset:0 lds
    buffer_load_dwordx4 v229, s[12:15], s67 offen offset:1024 lds
    buffer_load_dwordx4 v230, s[12:15], s67 offen offset:2048 lds
    buffer_load_dwordx4 v231, s[12:15], s67 offen offset:3072 lds
    s_add_u32 m0, s66, 61440
    s_nop 0
    buffer_load_dwordx4 v232, s[12:15], s67 offen offset:0 lds
    buffer_load_dwordx4 v233, s[12:15], s67 offen offset:1024 lds
    buffer_load_dwordx4 v234, s[12:15], s67 offen offset:2048 lds
    s_add_u32 s67, s67, 114688
    s_add_u32 m0, s66, 64512
    s_nop 0
    buffer_load_dwordx4 v228, s[12:15], s67 offen offset:0 lds
    buffer_load_dwordx4 v229, s[12:15], s67 offen offset:1024 lds
    buffer_load_dwordx4 v230, s[12:15], s67 offen offset:2048 lds
    buffer_load_dwordx4 v231, s[12:15], s67 offen offset:3072 lds
    s_add_u32 m0, s66, 68608
    s_nop 0
    buffer_load_dwordx4 v232, s[12:15], s67 offen offset:0 lds
    buffer_load_dwordx4 v233, s[12:15], s67 offen offset:1024 lds
    buffer_load_dwordx4 v234, s[12:15], s67 offen offset:2048 lds
    s_waitcnt vmcnt(14)
    s_barrier
    s_add_u32 s67, s64, 5
    s_and_b32 s67, s67, 15
    s_lshl_b32 s67, s67, 7
    s_add_u32 s67, s67, s62
    s_add_u32 m0, s65, 16384
    s_nop 0
    buffer_load_dwordx4 v224, s[8:11], s67 offen offset:0 lds
    buffer_load_dwordx4 v225, s[8:11], s67 offen offset:1024 lds
    buffer_load_dwordx4 v226, s[8:11], s67 offen offset:2048 lds
    buffer_load_dwordx4 v227, s[8:11], s67 offen offset:3072 lds
    s_add_u32 m0, s65, 20480
    s_add_u32 s67, s67, 65536
    buffer_load_dwordx4 v224, s[8:11], s67 offen offset:0 lds
    buffer_load_dwordx4 v225, s[8:11], s67 offen offset:1024 lds
    buffer_load_dwordx4 v226, s[8:11], s67 offen offset:2048 lds
    buffer_load_dwordx4 v227, s[8:11], s67 offen offset:3072 lds
    s_add_u32 s67, s64, 7
    s_and_b32 s67, s67, 15
    s_mul_i32 s67, s67, 458752
    s_add_u32 s67, s67, s63
    s_add_u32 m0, s66, 86016
    s_nop 0
    buffer_load_dwordx4 v228, s[12:15], s67 offen offset:0 lds
    buffer_load_dwordx4 v229, s[12:15], s67 offen offset:1024 lds
    buffer_load_dwordx4 v230, s[12:15], s67 offen offset:2048 lds
    buffer_load_dwordx4 v231, s[12:15], s67 offen offset:3072 lds
    s_add_u32 m0, s66, 90112
    s_nop 0
    buffer_load_dwordx4 v232, s[12:15], s67 offen offset:0 lds
    buffer_load_dwordx4 v233, s[12:15], s67 offen offset:1024 lds
    buffer_load_dwordx4 v234, s[12:15], s67 offen offset:2048 lds
    s_add_u32 s67, s67, 114688
    s_add_u32 m0, s66, 93184
    s_nop 0
    buffer_load_dwordx4 v228, s[12:15], s67 offen offset:0 lds
    buffer_load_dwordx4 v229, s[12:15], s67 offen offset:1024 lds
    buffer_load_dwordx4 v230, s[12:15], s67 offen offset:2048 lds
    buffer_load_dwordx4 v231, s[12:15], s67 offen offset:3072 lds
    s_add_u32 m0, s66, 97280
    s_nop 0
    buffer_load_dwordx4 v232, s[12:15], s67 offen offset:0 lds
    buffer_load_dwordx4 v233, s[12:15], s67 offen offset:1024 lds
    buffer_load_dwordx4 v234, s[12:15], s67 offen offset:2048 lds
    s_waitcnt vmcnt(14)
    s_barrier
    s_add_u32 s67, s64, 6
    s_and_b32 s67, s67, 15
    s_lshl_b32 s67, s67, 7
    s_add_u32 s67, s67, s62
    s_add_u32 m0, s65, 0
    s_nop 0
    buffer_load_dwordx4 v224, s[8:11], s67 offen offset:0 lds
    buffer_load_dwordx4 v225, s[8:11], s67 offen offset:1024 lds
    buffer_load_dwordx4 v226, s[8:11], s67 offen offset:2048 lds
    buffer_load_dwordx4 v227, s[8:11], s67 offen offset:3072 lds
    s_add_u32 m0, s65, 4096
    s_add_u32 s67, s67, 65536
    buffer_load_dwordx4 v224, s[8:11], s67 offen offset:0 lds
    buffer_load_dwordx4 v225, s[8:11], s67 offen offset:1024 lds
    buffer_load_dwordx4 v226, s[8:11], s67 offen offset:2048 lds
    buffer_load_dwordx4 v227, s[8:11], s67 offen offset:3072 lds
    s_add_u32 s67, s64, 8
    s_and_b32 s67, s67, 15
    s_mul_i32 s67, s67, 458752
    s_add_u32 s67, s67, s63
    s_add_u32 m0, s66, 0
    s_nop 0
    buffer_load_dwordx4 v228, s[12:15], s67 offen offset:0 lds
    buffer_load_dwordx4 v229, s[12:15], s67 offen offset:1024 lds
    buffer_load_dwordx4 v230, s[12:15], s67 offen offset:2048 lds
    buffer_load_dwordx4 v231, s[12:15], s67 offen offset:3072 lds
    s_add_u32 m0, s66, 4096
    s_nop 0
    buffer_load_dwordx4 v232, s[12:15], s67 offen offset:0 lds
    buffer_load_dwordx4 v233, s[12:15], s67 offen offset:1024 lds
    buffer_load_dwordx4 v234, s[12:15], s67 offen offset:2048 lds
    s_add_u32 s67, s67, 114688
    s_add_u32 m0, s66, 7168
    s_nop 0
    buffer_load_dwordx4 v228, s[12:15], s67 offen offset:0 lds
    buffer_load_dwordx4 v229, s[12:15], s67 offen offset:1024 lds
    buffer_load_dwordx4 v230, s[12:15], s67 offen offset:2048 lds
    buffer_load_dwordx4 v231, s[12:15], s67 offen offset:3072 lds
    s_add_u32 m0, s66, 11264
    s_nop 0
    buffer_load_dwordx4 v232, s[12:15], s67 offen offset:0 lds
    buffer_load_dwordx4 v233, s[12:15], s67 offen offset:1024 lds
    buffer_load_dwordx4 v234, s[12:15], s67 offen offset:2048 lds
    s_waitcnt vmcnt(14)
    s_barrier
    s_add_u32 s67, s64, 7
    s_and_b32 s67, s67, 15
    s_lshl_b32 s67, s67, 7
    s_add_u32 s67, s67, s62
    s_add_u32 m0, s65, 16384
    s_nop 0
    buffer_load_dwordx4 v224, s[8:11], s67 offen offset:0 lds
    buffer_load_dwordx4 v225, s[8:11], s67 offen offset:1024 lds
    buffer_load_dwordx4 v226, s[8:11], s67 offen offset:2048 lds
    buffer_load_dwordx4 v227, s[8:11], s67 offen offset:3072 lds
    s_add_u32 m0, s65, 20480
    s_add_u32 s67, s67, 65536
    buffer_load_dwordx4 v224, s[8:11], s67 offen offset:0 lds
    buffer_load_dwordx4 v225, s[8:11], s67 offen offset:1024 lds
    buffer_load_dwordx4 v226, s[8:11], s67 offen offset:2048 lds
    buffer_load_dwordx4 v227, s[8:11], s67 offen offset:3072 lds
    s_add_u32 s67, s64, 9
    s_and_b32 s67, s67, 15
    s_mul_i32 s67, s67, 458752
    s_add_u32 s67, s67, s63
    s_add_u32 m0, s66, 28672
    s_nop 0
    buffer_load_dwordx4 v228, s[12:15], s67 offen offset:0 lds
    buffer_load_dwordx4 v229, s[12:15], s67 offen offset:1024 lds
    buffer_load_dwordx4 v230, s[12:15], s67 offen offset:2048 lds
    buffer_load_dwordx4 v231, s[12:15], s67 offen offset:3072 lds
    s_add_u32 m0, s66, 32768
    s_nop 0
    buffer_load_dwordx4 v232, s[12:15], s67 offen offset:0 lds
    buffer_load_dwordx4 v233, s[12:15], s67 offen offset:1024 lds
    buffer_load_dwordx4 v234, s[12:15], s67 offen offset:2048 lds
    s_add_u32 s67, s67, 114688
    s_add_u32 m0, s66, 35840
    s_nop 0
    buffer_load_dwordx4 v228, s[12:15], s67 offen offset:0 lds
    buffer_load_dwordx4 v229, s[12:15], s67 offen offset:1024 lds
    buffer_load_dwordx4 v230, s[12:15], s67 offen offset:2048 lds
    buffer_load_dwordx4 v231, s[12:15], s67 offen offset:3072 lds
    s_add_u32 m0, s66, 39936
    s_nop 0
    buffer_load_dwordx4 v232, s[12:15], s67 offen offset:0 lds
    buffer_load_dwordx4 v233, s[12:15], s67 offen offset:1024 lds
    buffer_load_dwordx4 v234, s[12:15], s67 offen offset:2048 lds
    s_waitcnt vmcnt(14)
    s_barrier
    s_add_u32 s67, s64, 8
    s_and_b32 s67, s67, 15
    s_lshl_b32 s67, s67, 7
    s_add_u32 s67, s67, s62
    s_add_u32 m0, s65, 0
    s_nop 0
    buffer_load_dwordx4 v224, s[8:11], s67 offen offset:0 lds
    buffer_load_dwordx4 v225, s[8:11], s67 offen offset:1024 lds
    buffer_load_dwordx4 v226, s[8:11], s67 offen offset:2048 lds
    buffer_load_dwordx4 v227, s[8:11], s67 offen offset:3072 lds
    s_add_u32 m0, s65, 4096
    s_add_u32 s67, s67, 65536
    buffer_load_dwordx4 v224, s[8:11], s67 offen offset:0 lds
    buffer_load_dwordx4 v225, s[8:11], s67 offen offset:1024 lds
    buffer_load_dwordx4 v226, s[8:11], s67 offen offset:2048 lds
    buffer_load_dwordx4 v227, s[8:11], s67 offen offset:3072 lds
    s_add_u32 s67, s64, 10
    s_and_b32 s67, s67, 15
    s_mul_i32 s67, s67, 458752
    s_add_u32 s67, s67, s63
    s_add_u32 m0, s66, 57344
    s_nop 0
    buffer_load_dwordx4 v228, s[12:15], s67 offen offset:0 lds
    buffer_load_dwordx4 v229, s[12:15], s67 offen offset:1024 lds
    buffer_load_dwordx4 v230, s[12:15], s67 offen offset:2048 lds
    buffer_load_dwordx4 v231, s[12:15], s67 offen offset:3072 lds
    s_add_u32 m0, s66, 61440
    s_nop 0
    buffer_load_dwordx4 v232, s[12:15], s67 offen offset:0 lds
    buffer_load_dwordx4 v233, s[12:15], s67 offen offset:1024 lds
    buffer_load_dwordx4 v234, s[12:15], s67 offen offset:2048 lds
    s_add_u32 s67, s67, 114688
    s_add_u32 m0, s66, 64512
    s_nop 0
    buffer_load_dwordx4 v228, s[12:15], s67 offen offset:0 lds
    buffer_load_dwordx4 v229, s[12:15], s67 offen offset:1024 lds
    buffer_load_dwordx4 v230, s[12:15], s67 offen offset:2048 lds
    buffer_load_dwordx4 v231, s[12:15], s67 offen offset:3072 lds
    s_add_u32 m0, s66, 68608
    s_nop 0
    buffer_load_dwordx4 v232, s[12:15], s67 offen offset:0 lds
    buffer_load_dwordx4 v233, s[12:15], s67 offen offset:1024 lds
    buffer_load_dwordx4 v234, s[12:15], s67 offen offset:2048 lds
    s_waitcnt vmcnt(14)
    s_barrier
    s_add_u32 s67, s64, 9
    s_and_b32 s67, s67, 15
    s_lshl_b32 s67, s67, 7
    s_add_u32 s67, s67, s62
    s_add_u32 m0, s65, 16384
    s_nop 0
    buffer_load_dwordx4 v224, s[8:11], s67 offen offset:0 lds
    buffer_load_dwordx4 v225, s[8:11], s67 offen offset:1024 lds
    buffer_load_dwordx4 v226, s[8:11], s67 offen offset:2048 lds
    buffer_load_dwordx4 v227, s[8:11], s67 offen offset:3072 lds
    s_add_u32 m0, s65, 20480
    s_add_u32 s67, s67, 65536
    buffer_load_dwordx4 v224, s[8:11], s67 offen offset:0 lds
    buffer_load_dwordx4 v225, s[8:11], s67 offen offset:1024 lds
    buffer_load_dwordx4 v226, s[8:11], s67 offen offset:2048 lds
    buffer_load_dwordx4 v227, s[8:11], s67 offen offset:3072 lds
    s_add_u32 s67, s64, 11
    s_and_b32 s67, s67, 15
    s_mul_i32 s67, s67, 458752
    s_add_u32 s67, s67, s63
    s_add_u32 m0, s66, 86016
    s_nop 0
    buffer_load_dwordx4 v228, s[12:15], s67 offen offset:0 lds
    buffer_load_dwordx4 v229, s[12:15], s67 offen offset:1024 lds
    buffer_load_dwordx4 v230, s[12:15], s67 offen offset:2048 lds
    buffer_load_dwordx4 v231, s[12:15], s67 offen offset:3072 lds
    s_add_u32 m0, s66, 90112
    s_nop 0
    buffer_load_dwordx4 v232, s[12:15], s67 offen offset:0 lds
    buffer_load_dwordx4 v233, s[12:15], s67 offen offset:1024 lds
    buffer_load_dwordx4 v234, s[12:15], s67 offen offset:2048 lds
    s_add_u32 s67, s67, 114688
    s_add_u32 m0, s66, 93184
    s_nop 0
    buffer_load_dwordx4 v228, s[12:15], s67 offen offset:0 lds
    buffer_load_dwordx4 v229, s[12:15], s67 offen offset:1024 lds
    buffer_load_dwordx4 v230, s[12:15], s67 offen offset:2048 lds
    buffer_load_dwordx4 v231, s[12:15], s67 offen offset:3072 lds
    s_add_u32 m0, s66, 97280
    s_nop 0
    buffer_load_dwordx4 v232, s[12:15], s67 offen offset:0 lds
    buffer_load_dwordx4 v233, s[12:15], s67 offen offset:1024 lds
    buffer_load_dwordx4 v234, s[12:15], s67 offen offset:2048 lds
    s_waitcnt vmcnt(14)
    s_barrier
    s_add_u32 s67, s64, 10
    s_and_b32 s67, s67, 15
    s_lshl_b32 s67, s67, 7
    s_add_u32 s67, s67, s62
    s_add_u32 m0, s65, 0
    s_nop 0
    buffer_load_dwordx4 v224, s[8:11], s67 offen offset:0 lds
    buffer_load_dwordx4 v225, s[8:11], s67 offen offset:1024 lds
    buffer_load_dwordx4 v226, s[8:11], s67 offen offset:2048 lds
    buffer_load_dwordx4 v227, s[8:11], s67 offen offset:3072 lds
    s_add_u32 m0, s65, 4096
    s_add_u32 s67, s67, 65536
    buffer_load_dwordx4 v224, s[8:11], s67 offen offset:0 lds
    buffer_load_dwordx4 v225, s[8:11], s67 offen offset:1024 lds
    buffer_load_dwordx4 v226, s[8:11], s67 offen offset:2048 lds
    buffer_load_dwordx4 v227, s[8:11], s67 offen offset:3072 lds
    s_add_u32 s67, s64, 12
    s_and_b32 s67, s67, 15
    s_mul_i32 s67, s67, 458752
    s_add_u32 s67, s67, s63
    s_add_u32 m0, s66, 0
    s_nop 0
    buffer_load_dwordx4 v228, s[12:15], s67 offen offset:0 lds
    buffer_load_dwordx4 v229, s[12:15], s67 offen offset:1024 lds
    buffer_load_dwordx4 v230, s[12:15], s67 offen offset:2048 lds
    buffer_load_dwordx4 v231, s[12:15], s67 offen offset:3072 lds
    s_add_u32 m0, s66, 4096
    s_nop 0
    buffer_load_dwordx4 v232, s[12:15], s67 offen offset:0 lds
    buffer_load_dwordx4 v233, s[12:15], s67 offen offset:1024 lds
    buffer_load_dwordx4 v234, s[12:15], s67 offen offset:2048 lds
    s_add_u32 s67, s67, 114688
    s_add_u32 m0, s66, 7168
    s_nop 0
    buffer_load_dwordx4 v228, s[12:15], s67 offen offset:0 lds
    buffer_load_dwordx4 v229, s[12:15], s67 offen offset:1024 lds
    buffer_load_dwordx4 v230, s[12:15], s67 offen offset:2048 lds
    buffer_load_dwordx4 v231, s[12:15], s67 offen offset:3072 lds
    s_add_u32 m0, s66, 11264
    s_nop 0
    buffer_load_dwordx4 v232, s[12:15], s67 offen offset:0 lds
    buffer_load_dwordx4 v233, s[12:15], s67 offen offset:1024 lds
    buffer_load_dwordx4 v234, s[12:15], s67 offen offset:2048 lds
    s_waitcnt vmcnt(14)
    s_barrier
    s_add_u32 s67, s64, 11
    s_and_b32 s67, s67, 15
    s_lshl_b32 s67, s67, 7
    s_add_u32 s67, s67, s62
    s_add_u32 m0, s65, 16384
    s_nop 0
    buffer_load_dwordx4 v224, s[8:11], s67 offen offset:0 lds
    buffer_load_dwordx4 v225, s[8:11], s67 offen offset:1024 lds
    buffer_load_dwordx4 v226, s[8:11], s67 offen offset:2048 lds
    buffer_load_dwordx4 v227, s[8:11], s67 offen offset:3072 lds
    s_add_u32 m0, s65, 20480
    s_add_u32 s67, s67, 65536
    buffer_load_dwordx4 v224, s[8:11], s67 offen offset:0 lds
    buffer_load_dwordx4 v225, s[8:11], s67 offen offset:1024 lds
    buffer_load_dwordx4 v226, s[8:11], s67 offen offset:2048 lds
    buffer_load_dwordx4 v227, s[8:11], s67 offen offset:3072 lds
    s_add_u32 s67, s64, 13
    s_and_b32 s67, s67, 15
    s_mul_i32 s67, s67, 458752
    s_add_u32 s67, s67, s63
    s_add_u32 m0, s66, 28672
    s_nop 0
    buffer_load_dwordx4 v228, s[12:15], s67 offen offset:0 lds
    buffer_load_dwordx4 v229, s[12:15], s67 offen offset:1024 lds
    buffer_load_dwordx4 v230, s[12:15], s67 offen offset:2048 lds
    buffer_load_dwordx4 v231, s[12:15], s67 offen offset:3072 lds
    s_add_u32 m0, s66, 32768
    s_nop 0
    buffer_load_dwordx4 v232, s[12:15], s67 offen offset:0 lds
    buffer_load_dwordx4 v233, s[12:15], s67 offen offset:1024 lds
    buffer_load_dwordx4 v234, s[12:15], s67 offen offset:2048 lds
    s_add_u32 s67, s67, 114688
    s_add_u32 m0, s66, 35840
    s_nop 0
    buffer_load_dwordx4 v228, s[12:15], s67 offen offset:0 lds
    buffer_load_dwordx4 v229, s[12:15], s67 offen offset:1024 lds
    buffer_load_dwordx4 v230, s[12:15], s67 offen offset:2048 lds
    buffer_load_dwordx4 v231, s[12:15], s67 offen offset:3072 lds
    s_add_u32 m0, s66, 39936
    s_nop 0
    buffer_load_dwordx4 v232, s[12:15], s67 offen offset:0 lds
    buffer_load_dwordx4 v233, s[12:15], s67 offen offset:1024 lds
    buffer_load_dwordx4 v234, s[12:15], s67 offen offset:2048 lds
    s_waitcnt vmcnt(14)
    s_barrier
    s_add_u32 s67, s64, 12
    s_and_b32 s67, s67, 15
    s_lshl_b32 s67, s67, 7
    s_add_u32 s67, s67, s62
    s_add_u32 m0, s65, 0
    s_nop 0
    buffer_load_dwordx4 v224, s[8:11], s67 offen offset:0 lds
    buffer_load_dwordx4 v225, s[8:11], s67 offen offset:1024 lds
    buffer_load_dwordx4 v226, s[8:11], s67 offen offset:2048 lds
    buffer_load_dwordx4 v227, s[8:11], s67 offen offset:3072 lds
    s_add_u32 m0, s65, 4096
    s_add_u32 s67, s67, 65536
    buffer_load_dwordx4 v224, s[8:11], s67 offen offset:0 lds
    buffer_load_dwordx4 v225, s[8:11], s67 offen offset:1024 lds
    buffer_load_dwordx4 v226, s[8:11], s67 offen offset:2048 lds
    buffer_load_dwordx4 v227, s[8:11], s67 offen offset:3072 lds
    s_add_u32 s67, s64, 14
    s_and_b32 s67, s67, 15
    s_mul_i32 s67, s67, 458752
    s_add_u32 s67, s67, s63
    s_add_u32 m0, s66, 57344
    s_nop 0
    buffer_load_dwordx4 v228, s[12:15], s67 offen offset:0 lds
    buffer_load_dwordx4 v229, s[12:15], s67 offen offset:1024 lds
    buffer_load_dwordx4 v230, s[12:15], s67 offen offset:2048 lds
    buffer_load_dwordx4 v231, s[12:15], s67 offen offset:3072 lds
    s_add_u32 m0, s66, 61440
    s_nop 0
    buffer_load_dwordx4 v232, s[12:15], s67 offen offset:0 lds
    buffer_load_dwordx4 v233, s[12:15], s67 offen offset:1024 lds
    buffer_load_dwordx4 v234, s[12:15], s67 offen offset:2048 lds
    s_add_u32 s67, s67, 114688
    s_add_u32 m0, s66, 64512
    s_nop 0
    buffer_load_dwordx4 v228, s[12:15], s67 offen offset:0 lds
    buffer_load_dwordx4 v229, s[12:15], s67 offen offset:1024 lds
    buffer_load_dwordx4 v230, s[12:15], s67 offen offset:2048 lds
    buffer_load_dwordx4 v231, s[12:15], s67 offen offset:3072 lds
    s_add_u32 m0, s66, 68608
    s_nop 0
    buffer_load_dwordx4 v232, s[12:15], s67 offen offset:0 lds
    buffer_load_dwordx4 v233, s[12:15], s67 offen offset:1024 lds
    buffer_load_dwordx4 v234, s[12:15], s67 offen offset:2048 lds
    s_waitcnt vmcnt(14)
    s_barrier
    s_add_u32 s67, s64, 13
    s_and_b32 s67, s67, 15
    s_lshl_b32 s67, s67, 7
    s_add_u32 s67, s67, s62
    s_add_u32 m0, s65, 16384
    s_nop 0
    buffer_load_dwordx4 v224, s[8:11], s67 offen offset:0 lds
    buffer_load_dwordx4 v225, s[8:11], s67 offen offset:1024 lds
    buffer_load_dwordx4 v226, s[8:11], s67 offen offset:2048 lds
    buffer_load_dwordx4 v227, s[8:11], s67 offen offset:3072 lds
    s_add_u32 m0, s65, 20480
    s_add_u32 s67, s67, 65536
    buffer_load_dwordx4 v224, s[8:11], s67 offen offset:0 lds
    buffer_load_dwordx4 v225, s[8:11], s67 offen offset:1024 lds
    buffer_load_dwordx4 v226, s[8:11], s67 offen offset:2048 lds
    buffer_load_dwordx4 v227, s[8:11], s67 offen offset:3072 lds
    s_add_u32 s67, s64, 15
    s_and_b32 s67, s67, 15
    s_mul_i32 s67, s67, 458752
    s_add_u32 s67, s67, s63
    s_add_u32 m0, s66, 86016
    s_nop 0
    buffer_load_dwordx4 v228, s[12:15], s67 offen offset:0 lds
    buffer_load_dwordx4 v229, s[12:15], s67 offen offset:1024 lds
    buffer_load_dwordx4 v230, s[12:15], s67 offen offset:2048 lds
    buffer_load_dwordx4 v231, s[12:15], s67 offen offset:3072 lds
    s_add_u32 m0, s66, 90112
    s_nop 0
    buffer_load_dwordx4 v232, s[12:15], s67 offen offset:0 lds
    buffer_load_dwordx4 v233, s[12:15], s67 offen offset:1024 lds
    buffer_load_dwordx4 v234, s[12:15], s67 offen offset:2048 lds
    s_add_u32 s67, s67, 114688
    s_add_u32 m0, s66, 93184
    s_nop 0
    buffer_load_dwordx4 v228, s[12:15], s67 offen offset:0 lds
    buffer_load_dwordx4 v229, s[12:15], s67 offen offset:1024 lds
    buffer_load_dwordx4 v230, s[12:15], s67 offen offset:2048 lds
    buffer_load_dwordx4 v231, s[12:15], s67 offen offset:3072 lds
    s_add_u32 m0, s66, 97280
    s_nop 0
    buffer_load_dwordx4 v232, s[12:15], s67 offen offset:0 lds
    buffer_load_dwordx4 v233, s[12:15], s67 offen offset:1024 lds
    buffer_load_dwordx4 v234, s[12:15], s67 offen offset:2048 lds
    s_waitcnt vmcnt(14)
    s_barrier
    s_add_u32 s67, s64, 14
    s_and_b32 s67, s67, 15
    s_lshl_b32 s67, s67, 7
    s_add_u32 s67, s67, s62
    s_add_u32 m0, s65, 0
    s_nop 0
    buffer_load_dwordx4 v224, s[8:11], s67 offen offset:0 lds
    buffer_load_dwordx4 v225, s[8:11], s67 offen offset:1024 lds
    buffer_load_dwordx4 v226, s[8:11], s67 offen offset:2048 lds
    buffer_load_dwordx4 v227, s[8:11], s67 offen offset:3072 lds
    s_add_u32 m0, s65, 4096
    s_add_u32 s67, s67, 65536
    buffer_load_dwordx4 v224, s[8:11], s67 offen offset:0 lds
    buffer_load_dwordx4 v225, s[8:11], s67 offen offset:1024 lds
    buffer_load_dwordx4 v226, s[8:11], s67 offen offset:2048 lds
    buffer_load_dwordx4 v227, s[8:11], s67 offen offset:3072 lds
    s_waitcnt vmcnt(0)
    s_barrier
    s_add_u32 s67, s64, 15
    s_and_b32 s67, s67, 15
    s_lshl_b32 s67, s67, 7
    s_add_u32 s67, s67, s62
    s_add_u32 m0, s65, 16384
    s_nop 0
    buffer_load_dwordx4 v224, s[8:11], s67 offen offset:0 lds
    buffer_load_dwordx4 v225, s[8:11], s67 offen offset:1024 lds
    buffer_load_dwordx4 v226, s[8:11], s67 offen offset:2048 lds
    buffer_load_dwordx4 v227, s[8:11], s67 offen offset:3072 lds
    s_add_u32 m0, s65, 20480
    s_add_u32 s67, s67, 65536
    buffer_load_dwordx4 v224, s[8:11], s67 offen offset:0 lds
    buffer_load_dwordx4 v225, s[8:11], s67 offen offset:1024 lds
    buffer_load_dwordx4 v226, s[8:11], s67 offen offset:2048 lds
    buffer_load_dwordx4 v227, s[8:11], s67 offen offset:3072 lds
    s_waitcnt vmcnt(0)
    s_barrier
    s_add_u32 s68, s72, 0
    s_cmp_ge_u32 s68, 28
    s_cselect_b32 s67, 28, 0
    s_sub_u32 s68, s68, s67
    s_lshl_b32 s67, s68, 17
    s_add_u32 s67, s67, s71
    s_add_u32 m0, s65, 81920
    s_nop 0
    buffer_load_dwordx4 v220, s[16:19], s67 offen offset:0 lds
    buffer_load_dwordx4 v221, s[16:19], s67 offen offset:1024 lds
    buffer_load_dwordx4 v222, s[16:19], s67 offen offset:2048 lds
    buffer_load_dwordx4 v223, s[16:19], s67 offen offset:3072 lds
    s_add_u32 m0, s65, 86016
    s_add_u32 s67, s67, 32768
    buffer_load_dwordx4 v220, s[16:19], s67 offen offset:0 lds
    buffer_load_dwordx4 v221, s[16:19], s67 offen offset:1024 lds
    buffer_load_dwordx4 v222, s[16:19], s67 offen offset:2048 lds
    buffer_load_dwordx4 v223, s[16:19], s67 offen offset:3072 lds
    s_add_u32 s68, s72, 1
    s_cmp_ge_u32 s68, 28
    s_cselect_b32 s67, 28, 0
    s_sub_u32 s68, s68, s67
    s_lshl_b32 s67, s68, 17
    s_add_u32 s67, s67, s71
    s_add_u32 m0, s65, 98304
    s_nop 0
    buffer_load_dwordx4 v220, s[16:19], s67 offen offset:0 lds
    buffer_load_dwordx4 v221, s[16:19], s67 offen offset:1024 lds
    buffer_load_dwordx4 v222, s[16:19], s67 offen offset:2048 lds
    buffer_load_dwordx4 v223, s[16:19], s67 offen offset:3072 lds
    s_add_u32 m0, s65, 102400
    s_add_u32 s67, s67, 32768
    buffer_load_dwordx4 v220, s[16:19], s67 offen offset:0 lds
    buffer_load_dwordx4 v221, s[16:19], s67 offen offset:1024 lds
    buffer_load_dwordx4 v222, s[16:19], s67 offen offset:2048 lds
    buffer_load_dwordx4 v223, s[16:19], s67 offen offset:3072 lds
    s_barrier
    s_mul_i32 s62, s56, 917504
    s_mul_i32 s61, s74, 458752
    s_add_u32 s62, s62, s61
    s_add_u32 s62, s62, 65536
    s_add_u32 s62, s62, s65
    s_branch gated_mix__spectral_fnet__dense_activation_squared_relu__prompt_kernel_C2
gated_mix__spectral_fnet__dense_activation_squared_relu__prompt_kernel_S1:
    s_cmp_eq_u32 s3, 6
    s_cbranch_scc1 gated_mix__spectral_fnet__dense_activation_squared_relu__prompt_kernel_I1
    s_and_b32 s67, s7, 1
    s_lshl_b32 s69, s6, 5
    s_lshl_b32 s70, s67, 4
    s_add_u32 s69, s69, s70
    s_lshl_b32 s70, s74, 3
    s_add_u32 s70, s69, s70
    v_add_u32 v236, s70, v1
    v_lshlrev_b32 v236, 2, v236
    v_add_u32 v236, 25231360, v236
    s_xor_b32 s70, s5, 2
    s_lshl_b32 s70, s70, 2
    s_add_u32 s70, s70, 25235456
    v_writelane_b32 v236, s70, 8
    s_add_u32 s70, s69, s57
    s_lshl_b32 s70, s70, 2
    s_add_u32 s70, s70, 25231360
    v_writelane_b32 v236, s70, 9
    s_lshl_b32 s70, s5, 2
    s_add_u32 s70, s70, 25235456
    v_writelane_b32 v236, s70, 10
    s_mov_b64 exec, 0x7ff
    buffer_load_dword v237, v236, s[20:23], 0 offen sc1
    s_mov_b64 exec, -1
    s_mov_b32 s98, 0
    s_load_dword s99, s[40:41], s98
    s_mov_b32 s98, 2097152
    s_load_dword s99, s[40:41], s98
    s_mov_b32 s98, 4194304
    s_load_dword s99, s[40:41], s98
    s_mov_b32 s98, 6291456
    s_load_dword s99, s[40:41], s98
    s_mov_b32 s98, 20971520
    s_load_dword s99, s[50:51], s98
    s_mov_b32 s98, 23068672
    s_load_dword s99, s[50:51], s98
    s_mov_b32 s98, 0
    s_load_dword s99, s[46:47], s98
    s_mov_b32 s98, 2097152
    s_load_dword s99, s[46:47], s98
    s_mov_b32 s98, 2097152
    s_load_dword s99, s[36:37], s98
    s_mov_b32 s98, 4194304
    s_load_dword s99, s[36:37], s98
    s_mov_b32 s98, 6291456
    s_load_dword s99, s[36:37], s98
    v_and_b32 v2, 31, v1
    v_cvt_f32_u32 v2, v2
    v_mul_f32 v2, 0x3d000000, v2
    v_lshrrev_b32 v3, 5, v1
    v_cvt_f32_u32 v3, v3
    v_mul_f32 v3, 4.0, v3
    v_mul_f32 v3, v3, v2
    v_mul_f32 v4, 0x40a00000, v2
    v_fract_f32 v5, v3
    v_cos_f32 v96, v5
    v_sin_f32 v112, v5
    v_add_f32 v3, v3, v2
    v_fract_f32 v5, v3
    v_cos_f32 v97, v5
    v_sin_f32 v113, v5
    v_add_f32 v3, v3, v2
    v_fract_f32 v5, v3
    v_cos_f32 v98, v5
    v_sin_f32 v114, v5
    v_add_f32 v3, v3, v2
    v_fract_f32 v5, v3
    v_cos_f32 v99, v5
    v_sin_f32 v115, v5
    v_add_f32 v3, v3, v4
    v_fract_f32 v5, v3
    v_cos_f32 v100, v5
    v_sin_f32 v116, v5
    v_add_f32 v3, v3, v2
    v_fract_f32 v5, v3
    v_cos_f32 v101, v5
    v_sin_f32 v117, v5
    v_add_f32 v3, v3, v2
    v_fract_f32 v5, v3
    v_cos_f32 v102, v5
    v_sin_f32 v118, v5
    v_add_f32 v3, v3, v2
    v_fract_f32 v5, v3
    v_cos_f32 v103, v5
    v_sin_f32 v119, v5
    v_add_f32 v3, v3, v4
    v_fract_f32 v5, v3
    v_cos_f32 v104, v5
    v_sin_f32 v120, v5
    v_add_f32 v3, v3, v2
    v_fract_f32 v5, v3
    v_cos_f32 v105, v5
    v_sin_f32 v121, v5
    v_add_f32 v3, v3, v2
    v_fract_f32 v5, v3
    v_cos_f32 v106, v5
    v_sin_f32 v122, v5
    v_add_f32 v3, v3, v2
    v_fract_f32 v5, v3
    v_cos_f32 v107, v5
    v_sin_f32 v123, v5
    v_add_f32 v3, v3, v4
    v_fract_f32 v5, v3
    v_cos_f32 v108, v5
    v_sin_f32 v124, v5
    v_add_f32 v3, v3, v2
    v_fract_f32 v5, v3
    v_cos_f32 v109, v5
    v_sin_f32 v125, v5
    v_add_f32 v3, v3, v2
    v_fract_f32 v5, v3
    v_cos_f32 v110, v5
    v_sin_f32 v126, v5
    v_add_f32 v3, v3, v2
    v_fract_f32 v5, v3
    v_cos_f32 v111, v5
    v_sin_f32 v127, v5
    s_nop 0
    v_cvt_pk_bf16_f32 v16, v96, v97
    v_cvt_pk_bf16_f32 v24, v112, v113
    v_cvt_pk_bf16_f32 v17, v98, v99
    v_cvt_pk_bf16_f32 v25, v114, v115
    v_cvt_pk_bf16_f32 v18, v100, v101
    v_cvt_pk_bf16_f32 v26, v116, v117
    v_cvt_pk_bf16_f32 v19, v102, v103
    v_cvt_pk_bf16_f32 v27, v118, v119
    v_cvt_pk_bf16_f32 v20, v104, v105
    v_cvt_pk_bf16_f32 v28, v120, v121
    v_cvt_pk_bf16_f32 v21, v106, v107
    v_cvt_pk_bf16_f32 v29, v122, v123
    v_cvt_pk_bf16_f32 v22, v108, v109
    v_cvt_pk_bf16_f32 v30, v124, v125
    v_cvt_pk_bf16_f32 v23, v110, v111
    v_cvt_pk_bf16_f32 v31, v126, v127
    v_xor_b32 v32, 0x80008000, v24
    v_xor_b32 v33, 0x80008000, v25
    v_xor_b32 v34, 0x80008000, v26
    v_xor_b32 v35, 0x80008000, v27
    v_xor_b32 v36, 0x80008000, v28
    v_xor_b32 v37, 0x80008000, v29
    v_xor_b32 v38, 0x80008000, v30
    v_xor_b32 v39, 0x80008000, v31
    v_and_b32 v2, 31, v1
    v_cvt_f32_u32 v2, v2
    v_mul_f32 v2, 0x3a800000, v2
    v_lshrrev_b32 v3, 5, v1
    v_cvt_f32_u32 v3, v3
    v_mul_f32 v3, 4.0, v3
    v_mul_f32 v3, v3, v2
    v_mul_f32 v4, 0x40a00000, v2
    v_cos_f32 v96, v3
    v_sin_f32 v112, v3
    v_add_f32 v3, v3, v2
    v_cos_f32 v97, v3
    v_sin_f32 v113, v3
    v_add_f32 v3, v3, v2
    v_cos_f32 v98, v3
    v_sin_f32 v114, v3
    v_add_f32 v3, v3, v2
    v_cos_f32 v99, v3
    v_sin_f32 v115, v3
    v_add_f32 v3, v3, v4
    v_cos_f32 v100, v3
    v_sin_f32 v116, v3
    v_add_f32 v3, v3, v2
    v_cos_f32 v101, v3
    v_sin_f32 v117, v3
    v_add_f32 v3, v3, v2
    v_cos_f32 v102, v3
    v_sin_f32 v118, v3
    v_add_f32 v3, v3, v2
    v_cos_f32 v103, v3
    v_sin_f32 v119, v3
    v_add_f32 v3, v3, v4
    v_cos_f32 v104, v3
    v_sin_f32 v120, v3
    v_add_f32 v3, v3, v2
    v_cos_f32 v105, v3
    v_sin_f32 v121, v3
    v_add_f32 v3, v3, v2
    v_cos_f32 v106, v3
    v_sin_f32 v122, v3
    v_add_f32 v3, v3, v2
    v_cos_f32 v107, v3
    v_sin_f32 v123, v3
    v_add_f32 v3, v3, v4
    v_cos_f32 v108, v3
    v_sin_f32 v124, v3
    v_add_f32 v3, v3, v2
    v_cos_f32 v109, v3
    v_sin_f32 v125, v3
    v_add_f32 v3, v3, v2
    v_cos_f32 v110, v3
    v_sin_f32 v126, v3
    v_add_f32 v3, v3, v2
    v_cos_f32 v111, v3
    v_sin_f32 v127, v3
    v_and_b32 v2, 31, v1
    v_lshrrev_b32 v3, 5, v1
    v_lshlrev_b32 v5, 5, v2
    v_lshl_add_u32 v5, v3, 2, v5
    v_cvt_f32_u32 v5, v5
    v_mul_f32 v5, 0x3a000000, v5
    v_mov_b32 v4, 0x3a000000
    v_mov_b32 v7, 0x3b200000
    v_cos_f32 v176, v5
    v_sin_f32 v192, v5
    v_add_f32 v5, v5, v4
    v_cos_f32 v177, v5
    v_sin_f32 v193, v5
    v_add_f32 v5, v5, v4
    v_cos_f32 v178, v5
    v_sin_f32 v194, v5
    v_add_f32 v5, v5, v4
    v_cos_f32 v179, v5
    v_sin_f32 v195, v5
    v_add_f32 v5, v5, v7
    v_cos_f32 v180, v5
    v_sin_f32 v196, v5
    v_add_f32 v5, v5, v4
    v_cos_f32 v181, v5
    v_sin_f32 v197, v5
    v_add_f32 v5, v5, v4
    v_cos_f32 v182, v5
    v_sin_f32 v198, v5
    v_add_f32 v5, v5, v4
    v_cos_f32 v183, v5
    v_sin_f32 v199, v5
    v_add_f32 v5, v5, v7
    v_cos_f32 v184, v5
    v_sin_f32 v200, v5
    v_add_f32 v5, v5, v4
    v_cos_f32 v185, v5
    v_sin_f32 v201, v5
    v_add_f32 v5, v5, v4
    v_cos_f32 v186, v5
    v_sin_f32 v202, v5
    v_add_f32 v5, v5, v4
    v_cos_f32 v187, v5
    v_sin_f32 v203, v5
    v_add_f32 v5, v5, v7
    v_cos_f32 v188, v5
    v_sin_f32 v204, v5
    v_add_f32 v5, v5, v4
    v_cos_f32 v189, v5
    v_sin_f32 v205, v5
    v_add_f32 v5, v5, v4
    v_cos_f32 v190, v5
    v_sin_f32 v206, v5
    v_add_f32 v5, v5, v4
    v_cos_f32 v191, v5
    v_sin_f32 v207, v5
    s_barrier
    s_barrier
    v_mov_b32 v208, 0
    v_mov_b32 v209, 0
    v_mov_b32 v210, 0
    v_mov_b32 v211, 0
    s_sub_u32 s68, s57, s6
    s_add_u32 s68, s68, 8
    s_and_b32 s68, s68, 7
    s_cmp_ge_u32 s68, 3
    s_cbranch_scc1 gated_mix__spectral_fnet__dense_activation_squared_relu__prompt_kernel_jskip_0
    s_mul_i32 s68, s56, 917504
    s_mul_i32 s69, s57, 57344
    s_add_u32 s68, s68, s69
    s_add_u32 s68, s68, 65536
    s_add_u32 s67, s68, 0
    buffer_store_dwordx4 v[208:211], v235, s[20:23], s67 offen offset:0
    buffer_store_dwordx4 v[208:211], v235, s[20:23], s67 offen offset:1024
    buffer_store_dwordx4 v[208:211], v235, s[20:23], s67 offen offset:2048
    buffer_store_dwordx4 v[208:211], v235, s[20:23], s67 offen offset:3072
    s_add_u32 s67, s68, 4096
    buffer_store_dwordx4 v[208:211], v235, s[20:23], s67 offen offset:0
gated_mix__spectral_fnet__dense_activation_squared_relu__prompt_kernel_jskip_0:
    s_barrier
    s_sub_u32 s68, s57, s6
    s_add_u32 s68, s68, 8
    s_and_b32 s68, s68, 7
    s_cmp_ge_u32 s68, 3
    s_cbranch_scc1 gated_mix__spectral_fnet__dense_activation_squared_relu__prompt_kernel_jskip_1
    s_mul_i32 s68, s56, 917504
    s_mul_i32 s69, s57, 57344
    s_add_u32 s68, s68, s69
    s_add_u32 s68, s68, 65536
    s_add_u32 s67, s68, 4096
    buffer_store_dwordx4 v[208:211], v235, s[20:23], s67 offen offset:1024
    buffer_store_dwordx4 v[208:211], v235, s[20:23], s67 offen offset:2048
    buffer_store_dwordx4 v[208:211], v235, s[20:23], s67 offen offset:3072
    s_add_u32 s67, s68, 8192
    buffer_store_dwordx4 v[208:211], v235, s[20:23], s67 offen offset:0
    buffer_store_dwordx4 v[208:211], v235, s[20:23], s67 offen offset:1024
gated_mix__spectral_fnet__dense_activation_squared_relu__prompt_kernel_jskip_1:
    s_barrier
    s_sub_u32 s68, s57, s6
    s_add_u32 s68, s68, 8
    s_and_b32 s68, s68, 7
    s_cmp_ge_u32 s68, 3
    s_cbranch_scc1 gated_mix__spectral_fnet__dense_activation_squared_relu__prompt_kernel_jskip_2
    s_mul_i32 s68, s56, 917504
    s_mul_i32 s69, s57, 57344
    s_add_u32 s68, s68, s69
    s_add_u32 s68, s68, 65536
    s_add_u32 s67, s68, 8192
    buffer_store_dwordx4 v[208:211], v235, s[20:23], s67 offen offset:2048
    buffer_store_dwordx4 v[208:211], v235, s[20:23], s67 offen offset:3072
    s_add_u32 s67, s68, 12288
    buffer_store_dwordx4 v[208:211], v235, s[20:23], s67 offen offset:0
    buffer_store_dwordx4 v[208:211], v235, s[20:23], s67 offen offset:1024
    buffer_store_dwordx4 v[208:211], v235, s[20:23], s67 offen offset:2048
gated_mix__spectral_fnet__dense_activation_squared_relu__prompt_kernel_jskip_2:
    s_waitcnt vmcnt(0)
    v_add_u32 v237, 1, v237
    s_barrier
    s_mov_b64 exec, 1
    s_mul_i32 s67, s96, 6
    s_mov_b64 s[68:69], 1
    s_lshl_b64 s[68:69], s[68:69], s67
    v_mov_b32 v240, s68
    v_mov_b32 v241, s69
    s_lshl_b32 s67, s6, 5
    v_mov_b32 v239, s67
    buffer_atomic_add_x2 v[240:241], v239, s[28:31], 0 offen
    s_mov_b64 exec, -1
    s_sub_u32 s68, s57, s6
    s_add_u32 s68, s68, 8
    s_and_b32 s68, s68, 7
    s_cmp_ge_u32 s68, 3
    s_cbranch_scc1 gated_mix__spectral_fnet__dense_activation_squared_relu__prompt_kernel_jskip_3
    s_mul_i32 s68, s56, 917504
    s_mul_i32 s69, s57, 57344
    s_add_u32 s68, s68, s69
    s_add_u32 s68, s68, 65536
    s_add_u32 s67, s68, 12288
    buffer_store_dwordx4 v[208:211], v235, s[20:23], s67 offen offset:3072
    s_add_u32 s67, s68, 16384
    buffer_store_dwordx4 v[208:211], v235, s[20:23], s67 offen offset:0
    buffer_store_dwordx4 v[208:211], v235, s[20:23], s67 offen offset:1024
    buffer_store_dwordx4 v[208:211], v235, s[20:23], s67 offen offset:2048
    buffer_store_dwordx4 v[208:211], v235, s[20:23], s67 offen offset:3072
gated_mix__spectral_fnet__dense_activation_squared_relu__prompt_kernel_jskip_3:
    s_barrier
    s_sub_u32 s68, s57, s6
    s_add_u32 s68, s68, 8
    s_and_b32 s68, s68, 7
    s_cmp_ge_u32 s68, 3
    s_cbranch_scc1 gated_mix__spectral_fnet__dense_activation_squared_relu__prompt_kernel_jskip_4
    s_mul_i32 s68, s56, 917504
    s_mul_i32 s69, s57, 57344
    s_add_u32 s68, s68, s69
    s_add_u32 s68, s68, 65536
    s_add_u32 s67, s68, 20480
    buffer_store_dwordx4 v[208:211], v235, s[20:23], s67 offen offset:0
    buffer_store_dwordx4 v[208:211], v235, s[20:23], s67 offen offset:1024
    buffer_store_dwordx4 v[208:211], v235, s[20:23], s67 offen offset:2048
    buffer_store_dwordx4 v[208:211], v235, s[20:23], s67 offen offset:3072
    s_add_u32 s67, s68, 24576
    buffer_store_dwordx4 v[208:211], v235, s[20:23], s67 offen offset:0
gated_mix__spectral_fnet__dense_activation_squared_relu__prompt_kernel_jskip_4:
    s_barrier
    s_sub_u32 s68, s57, s6
    s_add_u32 s68, s68, 8
    s_and_b32 s68, s68, 7
    s_cmp_ge_u32 s68, 3
    s_cbranch_scc1 gated_mix__spectral_fnet__dense_activation_squared_relu__prompt_kernel_jskip_5
    s_mul_i32 s68, s56, 917504
    s_mul_i32 s69, s57, 57344
    s_add_u32 s68, s68, s69
    s_add_u32 s68, s68, 65536
    s_add_u32 s67, s68, 24576
    buffer_store_dwordx4 v[208:211], v235, s[20:23], s67 offen offset:1024
    buffer_store_dwordx4 v[208:211], v235, s[20:23], s67 offen offset:2048
    buffer_store_dwordx4 v[208:211], v235, s[20:23], s67 offen offset:3072
    s_add_u32 s67, s68, 28672
    buffer_store_dwordx4 v[208:211], v235, s[20:23], s67 offen offset:0
    buffer_store_dwordx4 v[208:211], v235, s[20:23], s67 offen offset:1024
gated_mix__spectral_fnet__dense_activation_squared_relu__prompt_kernel_jskip_5:
    s_barrier
    s_sub_u32 s68, s57, s6
    s_add_u32 s68, s68, 8
    s_and_b32 s68, s68, 7
    s_cmp_ge_u32 s68, 3
    s_cbranch_scc1 gated_mix__spectral_fnet__dense_activation_squared_relu__prompt_kernel_jskip_6
    s_mul_i32 s68, s56, 917504
    s_mul_i32 s69, s57, 57344
    s_add_u32 s68, s68, s69
    s_add_u32 s68, s68, 65536
    s_add_u32 s67, s68, 28672
    buffer_store_dwordx4 v[208:211], v235, s[20:23], s67 offen offset:2048
    buffer_store_dwordx4 v[208:211], v235, s[20:23], s67 offen offset:3072
    s_add_u32 s67, s68, 32768
    buffer_store_dwordx4 v[208:211], v235, s[20:23], s67 offen offset:0
    buffer_store_dwordx4 v[208:211], v235, s[20:23], s67 offen offset:1024
    buffer_store_dwordx4 v[208:211], v235, s[20:23], s67 offen offset:2048
gated_mix__spectral_fnet__dense_activation_squared_relu__prompt_kernel_jskip_6:
    s_barrier
    s_sub_u32 s68, s57, s6
    s_add_u32 s68, s68, 8
    s_and_b32 s68, s68, 7
    s_cmp_ge_u32 s68, 3
    s_cbranch_scc1 gated_mix__spectral_fnet__dense_activation_squared_relu__prompt_kernel_jskip_7
    s_mul_i32 s68, s56, 917504
    s_mul_i32 s69, s57, 57344
    s_add_u32 s68, s68, s69
    s_add_u32 s68, s68, 65536
    s_add_u32 s67, s68, 32768
    buffer_store_dwordx4 v[208:211], v235, s[20:23], s67 offen offset:3072
    s_add_u32 s67, s68, 36864
    buffer_store_dwordx4 v[208:211], v235, s[20:23], s67 offen offset:0
    buffer_store_dwordx4 v[208:211], v235, s[20:23], s67 offen offset:1024
    buffer_store_dwordx4 v[208:211], v235, s[20:23], s67 offen offset:2048
    buffer_store_dwordx4 v[208:211], v235, s[20:23], s67 offen offset:3072
gated_mix__spectral_fnet__dense_activation_squared_relu__prompt_kernel_jskip_7:
    s_barrier
    s_sub_u32 s68, s57, s6
    s_add_u32 s68, s68, 8
    s_and_b32 s68, s68, 7
    s_cmp_ge_u32 s68, 3
    s_cbranch_scc1 gated_mix__spectral_fnet__dense_activation_squared_relu__prompt_kernel_jskip_8
    s_mul_i32 s68, s56, 917504
    s_mul_i32 s69, s57, 57344
    s_add_u32 s68, s68, s69
    s_add_u32 s68, s68, 65536
    s_add_u32 s67, s68, 40960
    buffer_store_dwordx4 v[208:211], v235, s[20:23], s67 offen offset:0
    buffer_store_dwordx4 v[208:211], v235, s[20:23], s67 offen offset:1024
    buffer_store_dwordx4 v[208:211], v235, s[20:23], s67 offen offset:2048
    buffer_store_dwordx4 v[208:211], v235, s[20:23], s67 offen offset:3072
    s_add_u32 s67, s68, 45056
    buffer_store_dwordx4 v[208:211], v235, s[20:23], s67 offen offset:0
gated_mix__spectral_fnet__dense_activation_squared_relu__prompt_kernel_jskip_8:
    s_barrier
    s_sub_u32 s68, s57, s6
    s_add_u32 s68, s68, 8
    s_and_b32 s68, s68, 7
    s_cmp_ge_u32 s68, 3
    s_cbranch_scc1 gated_mix__spectral_fnet__dense_activation_squared_relu__prompt_kernel_jskip_9
    s_mul_i32 s68, s56, 917504
    s_mul_i32 s69, s57, 57344
    s_add_u32 s68, s68, s69
    s_add_u32 s68, s68, 65536
    s_add_u32 s67, s68, 45056
    buffer_store_dwordx4 v[208:211], v235, s[20:23], s67 offen offset:1024
    buffer_store_dwordx4 v[208:211], v235, s[20:23], s67 offen offset:2048
    buffer_store_dwordx4 v[208:211], v235, s[20:23], s67 offen offset:3072
    s_add_u32 s67, s68, 49152
    buffer_store_dwordx4 v[208:211], v235, s[20:23], s67 offen offset:0
    buffer_store_dwordx4 v[208:211], v235, s[20:23], s67 offen offset:1024
gated_mix__spectral_fnet__dense_activation_squared_relu__prompt_kernel_jskip_9:
    s_barrier
    s_sub_u32 s68, s57, s6
    s_add_u32 s68, s68, 8
    s_and_b32 s68, s68, 7
    s_cmp_ge_u32 s68, 3
    s_cbranch_scc1 gated_mix__spectral_fnet__dense_activation_squared_relu__prompt_kernel_jskip_10
    s_mul_i32 s68, s56, 917504
    s_mul_i32 s69, s57, 57344
    s_add_u32 s68, s68, s69
    s_add_u32 s68, s68, 65536
    s_add_u32 s67, s68, 49152
    buffer_store_dwordx4 v[208:211], v235, s[20:23], s67 offen offset:2048
    buffer_store_dwordx4 v[208:211], v235, s[20:23], s67 offen offset:3072
    s_add_u32 s67, s68, 53248
    buffer_store_dwordx4 v[208:211], v235, s[20:23], s67 offen offset:0
    buffer_store_dwordx4 v[208:211], v235, s[20:23], s67 offen offset:1024
    buffer_store_dwordx4 v[208:211], v235, s[20:23], s67 offen offset:2048
gated_mix__spectral_fnet__dense_activation_squared_relu__prompt_kernel_jskip_10:
    s_barrier
    s_mov_b64 exec, 0xff
    v_lshlrev_b32 v239, 5, v1
    buffer_load_dwordx4 v[240:243], v239, s[28:31], 0 offen sc1
    s_mov_b64 exec, -1
    s_sub_u32 s68, s57, s6
    s_add_u32 s68, s68, 8
    s_and_b32 s68, s68, 7
    s_cmp_ge_u32 s68, 3
    s_cbranch_scc1 gated_mix__spectral_fnet__dense_activation_squared_relu__prompt_kernel_jskip_11
    s_mul_i32 s68, s56, 917504
    s_mul_i32 s69, s57, 57344
    s_add_u32 s68, s68, s69
    s_add_u32 s68, s68, 65536
    s_add_u32 s67, s68, 53248
    buffer_store_dwordx4 v[208:211], v235, s[20:23], s67 offen offset:3072
gated_mix__spectral_fnet__dense_activation_squared_relu__prompt_kernel_jskip_11:
    s_barrier
    s_waitcnt vmcnt(0)
    s_mov_b64 exec, 0xff
    v_cmp_ne_u32 vcc, 32, v243
    s_nop 4
    s_cbranch_vccz gated_mix__spectral_fnet__dense_activation_squared_relu__prompt_kernel_vpoll_d
    s_mov_b32 s76, 200000
gated_mix__spectral_fnet__dense_activation_squared_relu__prompt_kernel_vpoll:
    buffer_load_dwordx4 v[240:243], v239, s[28:31], 0 offen sc1
    s_waitcnt vmcnt(0)
    v_cmp_ne_u32 vcc, 32, v243
    s_nop 4
    s_cbranch_vccz gated_mix__spectral_fnet__dense_activation_squared_relu__prompt_kernel_vpoll_d
    s_sub_u32 s76, s76, 1
    s_cmp_eq_u32 s76, 0
    s_cbranch_scc1 gated_mix__spectral_fnet__dense_activation_squared_relu__prompt_kernel_vpoll_d
    s_sleep 1
    s_branch gated_mix__spectral_fnet__dense_activation_squared_relu__prompt_kernel_vpoll
gated_mix__spectral_fnet__dense_activation_squared_relu__prompt_kernel_vpoll_d:
    s_mov_b32 s76, 200000
gated_mix__spectral_fnet__dense_activation_squared_relu__prompt_kernel_smchk:
    v_readlane_b32 s60, v240, s6
    v_readlane_b32 s61, v241, s6
    s_mov_b32 s62, 0
    s_mov_b32 s63, 1
    s_lshr_b64 s[68:69], s[60:61], 0
    s_and_b32 s68, s68, 63
    s_add_u32 s62, s62, s68
    s_cmp_eq_u32 s68, 32
    s_cselect_b32 s63, 0, s63
    s_lshr_b64 s[68:69], s[60:61], 6
    s_and_b32 s68, s68, 63
    s_add_u32 s62, s62, s68
    s_cmp_eq_u32 s68, 32
    s_cselect_b32 s63, 0, s63
    s_lshr_b64 s[68:69], s[60:61], 12
    s_and_b32 s68, s68, 63
    s_add_u32 s62, s62, s68
    s_cmp_eq_u32 s68, 32
    s_cselect_b32 s63, 0, s63
    s_lshr_b64 s[68:69], s[60:61], 18
    s_and_b32 s68, s68, 63
    s_add_u32 s62, s62, s68
    s_cmp_eq_u32 s68, 32
    s_cselect_b32 s63, 0, s63
    s_lshr_b64 s[68:69], s[60:61], 24
    s_and_b32 s68, s68, 63
    s_add_u32 s62, s62, s68
    s_cmp_eq_u32 s68, 32
    s_cselect_b32 s63, 0, s63
    s_lshr_b64 s[68:69], s[60:61], 30
    s_and_b32 s68, s68, 63
    s_add_u32 s62, s62, s68
    s_cmp_eq_u32 s68, 32
    s_cselect_b32 s63, 0, s63
    s_lshr_b64 s[68:69], s[60:61], 36
    s_and_b32 s68, s68, 63
    s_add_u32 s62, s62, s68
    s_cmp_eq_u32 s68, 32
    s_cselect_b32 s63, 0, s63
    s_lshr_b64 s[68:69], s[60:61], 42
    s_and_b32 s68, s68, 63
    s_add_u32 s62, s62, s68
    s_cmp_eq_u32 s68, 32
    s_cselect_b32 s63, 0, s63
    s_cmp_eq_u32 s62, 32
    s_cbranch_scc1 gated_mix__spectral_fnet__dense_activation_squared_relu__prompt_kernel_smok
    s_sub_u32 s76, s76, 1
    s_cmp_eq_u32 s76, 0
    s_cbranch_scc1 gated_mix__spectral_fnet__dense_activation_squared_relu__prompt_kernel_smok
    s_sleep 2
    buffer_load_dwordx4 v[240:243], v239, s[28:31], 0 offen sc1
    s_waitcnt vmcnt(0)
    s_branch gated_mix__spectral_fnet__dense_activation_squared_relu__prompt_kernel_smchk
gated_mix__spectral_fnet__dense_activation_squared_relu__prompt_kernel_smok:
    s_mov_b32 s54, s63
    s_mov_b64 exec, -1
    s_barrier
    v_mov_b32 v238, 61504
    v_mov_b32 v239, s54
    ds_write_b32 v238, v239
    s_lshl_b32 s61, s5, 14
    s_add_u32 s61, s61, 16777216
    s_mov_b32 m0, 147456
    s_add_u32 s67, s61, 0
    buffer_load_dwordx4 v235, s[20:23], s67 offen offset:0 sc1 lds
    buffer_load_dwordx4 v235, s[20:23], s67 offen offset:1024 sc1 lds
    buffer_load_dwordx4 v235, s[20:23], s67 offen offset:2048 sc1 lds
    buffer_load_dwordx4 v235, s[20:23], s67 offen offset:3072 sc1 lds
    s_mov_b32 m0, 151552
    s_add_u32 s67, s61, 4096
    buffer_load_dwordx4 v235, s[20:23], s67 offen offset:0 sc1 lds
    buffer_load_dwordx4 v235, s[20:23], s67 offen offset:1024 sc1 lds
    buffer_load_dwordx4 v235, s[20:23], s67 offen offset:2048 sc1 lds
    buffer_load_dwordx4 v235, s[20:23], s67 offen offset:3072 sc1 lds
    s_mov_b32 m0, 155648
    s_add_u32 s67, s61, 8192
    buffer_load_dwordx4 v235, s[20:23], s67 offen offset:0 sc1 lds
    buffer_load_dwordx4 v235, s[20:23], s67 offen offset:1024 sc1 lds
    buffer_load_dwordx4 v235, s[20:23], s67 offen offset:2048 sc1 lds
    buffer_load_dwordx4 v235, s[20:23], s67 offen offset:3072 sc1 lds
    s_mov_b32 m0, 159744
    s_add_u32 s67, s61, 12288
    buffer_load_dwordx4 v235, s[20:23], s67 offen offset:0 sc1 lds
    buffer_load_dwordx4 v235, s[20:23], s67 offen offset:1024 sc1 lds
    buffer_load_dwordx4 v235, s[20:23], s67 offen offset:2048 sc1 lds
    buffer_load_dwordx4 v235, s[20:23], s67 offen offset:3072 sc1 lds
    s_waitcnt lgkmcnt(0)
    s_barrier
    s_waitcnt vmcnt(0)
    s_barrier
    s_branch gated_mix__spectral_fnet__dense_activation_squared_relu__prompt_kernel_C2
gated_mix__spectral_fnet__dense_activation_squared_relu__prompt_kernel_I1:
    v_and_b32 v2, 31, v1
    v_cvt_f32_u32 v2, v2
    v_mul_f32 v2, 0x3d000000, v2
    v_lshrrev_b32 v3, 5, v1
    v_cvt_f32_u32 v3, v3
    v_mul_f32 v3, 4.0, v3
    v_mul_f32 v3, v3, v2
    v_mul_f32 v4, 0x40a00000, v2
    v_fract_f32 v5, v3
    v_cos_f32 v96, v5
    v_sin_f32 v112, v5
    v_add_f32 v3, v3, v2
    v_fract_f32 v5, v3
    v_cos_f32 v97, v5
    v_sin_f32 v113, v5
    v_add_f32 v3, v3, v2
    v_fract_f32 v5, v3
    v_cos_f32 v98, v5
    v_sin_f32 v114, v5
    v_add_f32 v3, v3, v2
    v_fract_f32 v5, v3
    v_cos_f32 v99, v5
    v_sin_f32 v115, v5
    v_add_f32 v3, v3, v4
    v_fract_f32 v5, v3
    v_cos_f32 v100, v5
    v_sin_f32 v116, v5
    v_add_f32 v3, v3, v2
    v_fract_f32 v5, v3
    v_cos_f32 v101, v5
    v_sin_f32 v117, v5
    v_add_f32 v3, v3, v2
    v_fract_f32 v5, v3
    v_cos_f32 v102, v5
    v_sin_f32 v118, v5
    v_add_f32 v3, v3, v2
    v_fract_f32 v5, v3
    v_cos_f32 v103, v5
    v_sin_f32 v119, v5
    v_add_f32 v3, v3, v4
    v_fract_f32 v5, v3
    v_cos_f32 v104, v5
    v_sin_f32 v120, v5
    v_add_f32 v3, v3, v2
    v_fract_f32 v5, v3
    v_cos_f32 v105, v5
    v_sin_f32 v121, v5
    v_add_f32 v3, v3, v2
    v_fract_f32 v5, v3
    v_cos_f32 v106, v5
    v_sin_f32 v122, v5
    v_add_f32 v3, v3, v2
    v_fract_f32 v5, v3
    v_cos_f32 v107, v5
    v_sin_f32 v123, v5
    v_add_f32 v3, v3, v4
    v_fract_f32 v5, v3
    v_cos_f32 v108, v5
    v_sin_f32 v124, v5
    v_add_f32 v3, v3, v2
    v_fract_f32 v5, v3
    v_cos_f32 v109, v5
    v_sin_f32 v125, v5
    v_add_f32 v3, v3, v2
    v_fract_f32 v5, v3
    v_cos_f32 v110, v5
    v_sin_f32 v126, v5
    v_add_f32 v3, v3, v2
    v_fract_f32 v5, v3
    v_cos_f32 v111, v5
    v_sin_f32 v127, v5
    s_nop 0
    v_cvt_pk_bf16_f32 v16, v96, v97
    v_cvt_pk_bf16_f32 v24, v112, v113
    v_cvt_pk_bf16_f32 v17, v98, v99
    v_cvt_pk_bf16_f32 v25, v114, v115
    v_cvt_pk_bf16_f32 v18, v100, v101
    v_cvt_pk_bf16_f32 v26, v116, v117
    v_cvt_pk_bf16_f32 v19, v102, v103
    v_cvt_pk_bf16_f32 v27, v118, v119
    v_cvt_pk_bf16_f32 v20, v104, v105
    v_cvt_pk_bf16_f32 v28, v120, v121
    v_cvt_pk_bf16_f32 v21, v106, v107
    v_cvt_pk_bf16_f32 v29, v122, v123
    v_cvt_pk_bf16_f32 v22, v108, v109
    v_cvt_pk_bf16_f32 v30, v124, v125
    v_cvt_pk_bf16_f32 v23, v110, v111
    v_cvt_pk_bf16_f32 v31, v126, v127
    v_xor_b32 v32, 0x80008000, v24
    v_xor_b32 v33, 0x80008000, v25
    v_xor_b32 v34, 0x80008000, v26
    v_xor_b32 v35, 0x80008000, v27
    v_xor_b32 v36, 0x80008000, v28
    v_xor_b32 v37, 0x80008000, v29
    v_xor_b32 v38, 0x80008000, v30
    v_xor_b32 v39, 0x80008000, v31
    v_and_b32 v2, 31, v1
    v_cvt_f32_u32 v2, v2
    v_mul_f32 v2, 0x3a800000, v2
    v_lshrrev_b32 v3, 5, v1
    v_cvt_f32_u32 v3, v3
    v_mul_f32 v3, 4.0, v3
    v_mul_f32 v3, v3, v2
    v_mul_f32 v4, 0x40a00000, v2
    v_cos_f32 v96, v3
    v_sin_f32 v112, v3
    v_add_f32 v3, v3, v2
    v_cos_f32 v97, v3
    v_sin_f32 v113, v3
    v_add_f32 v3, v3, v2
    v_cos_f32 v98, v3
    v_sin_f32 v114, v3
    v_add_f32 v3, v3, v2
    v_cos_f32 v99, v3
    v_sin_f32 v115, v3
    v_add_f32 v3, v3, v4
    v_cos_f32 v100, v3
    v_sin_f32 v116, v3
    v_add_f32 v3, v3, v2
    v_cos_f32 v101, v3
    v_sin_f32 v117, v3
    v_add_f32 v3, v3, v2
    v_cos_f32 v102, v3
    v_sin_f32 v118, v3
    v_add_f32 v3, v3, v2
    v_cos_f32 v103, v3
    v_sin_f32 v119, v3
    v_add_f32 v3, v3, v4
    v_cos_f32 v104, v3
    v_sin_f32 v120, v3
    v_add_f32 v3, v3, v2
    v_cos_f32 v105, v3
    v_sin_f32 v121, v3
    v_add_f32 v3, v3, v2
    v_cos_f32 v106, v3
    v_sin_f32 v122, v3
    v_add_f32 v3, v3, v2
    v_cos_f32 v107, v3
    v_sin_f32 v123, v3
    v_add_f32 v3, v3, v4
    v_cos_f32 v108, v3
    v_sin_f32 v124, v3
    v_add_f32 v3, v3, v2
    v_cos_f32 v109, v3
    v_sin_f32 v125, v3
    v_add_f32 v3, v3, v2
    v_cos_f32 v110, v3
    v_sin_f32 v126, v3
    v_add_f32 v3, v3, v2
    v_cos_f32 v111, v3
    v_sin_f32 v127, v3
    v_and_b32 v2, 31, v1
    v_lshrrev_b32 v3, 5, v1
    v_lshlrev_b32 v5, 5, v2
    v_lshl_add_u32 v5, v3, 2, v5
    v_cvt_f32_u32 v5, v5
    v_mul_f32 v5, 0x3a000000, v5
    v_mov_b32 v4, 0x3a000000
    v_mov_b32 v7, 0x3b200000
    v_cos_f32 v176, v5
    v_sin_f32 v192, v5
    v_add_f32 v5, v5, v4
    v_cos_f32 v177, v5
    v_sin_f32 v193, v5
    v_add_f32 v5, v5, v4
    v_cos_f32 v178, v5
    v_sin_f32 v194, v5
    v_add_f32 v5, v5, v4
    v_cos_f32 v179, v5
    v_sin_f32 v195, v5
    v_add_f32 v5, v5, v7
    v_cos_f32 v180, v5
    v_sin_f32 v196, v5
    v_add_f32 v5, v5, v4
    v_cos_f32 v181, v5
    v_sin_f32 v197, v5
    v_add_f32 v5, v5, v4
    v_cos_f32 v182, v5
    v_sin_f32 v198, v5
    v_add_f32 v5, v5, v4
    v_cos_f32 v183, v5
    v_sin_f32 v199, v5
    v_add_f32 v5, v5, v7
    v_cos_f32 v184, v5
    v_sin_f32 v200, v5
    v_add_f32 v5, v5, v4
    v_cos_f32 v185, v5
    v_sin_f32 v201, v5
    v_add_f32 v5, v5, v4
    v_cos_f32 v186, v5
    v_sin_f32 v202, v5
    v_add_f32 v5, v5, v4
    v_cos_f32 v187, v5
    v_sin_f32 v203, v5
    v_add_f32 v5, v5, v7
    v_cos_f32 v188, v5
    v_sin_f32 v204, v5
    v_add_f32 v5, v5, v4
    v_cos_f32 v189, v5
    v_sin_f32 v205, v5
    v_add_f32 v5, v5, v4
    v_cos_f32 v190, v5
    v_sin_f32 v206, v5
    v_add_f32 v5, v5, v4
    v_cos_f32 v191, v5
    v_sin_f32 v207, v5
    v_lshrrev_b32 v2, 2, v1
    v_and_b32 v3, 3, v1
    v_lshlrev_b32 v244, 14, v2
    v_lshl_add_u32 v244, v3, 4, v244
    v_and_b32 v4, 1, v3
    v_lshl_add_u32 v4, v2, 1, v4
    v_lshrrev_b32 v5, 1, v3
    v_cmp_eq_u32 vcc, 0, v5
    v_sub_u32 v6, 1024, v4
    v_cndmask_b32 v12, v6, v4, vcc
    v_lshlrev_b32 v245, 4, v12
    v_add_u32 v245, 147456, v245
    v_mov_b32 v14, 512
    v_mov_b32 v15, -512
    v_cndmask_b32 v246, v15, v14, vcc
    v_cmp_eq_u32 vcc, 1024, v12
    v_mov_b32 v14, 155648
    s_nop 0
    v_cndmask_b32 v247, v245, v14, vcc
    s_mov_b32 s77, 0x05040100
    s_mov_b32 s78, 0x07060302
    s_lshl_b32 s79, s5, 6
    s_add_u32 s79, s79, 16777216
    s_barrier
    ds_read_b128 v[208:211], v247
    s_waitcnt lgkmcnt(0)
    v_perm_b32 v216, v209, v208, s77
    v_perm_b32 v217, v211, v210, s77
    v_perm_b32 v218, v209, v208, s78
    v_perm_b32 v219, v211, v210, s78
    s_add_u32 s61, s79, 0
    buffer_store_dwordx4 v[216:219], v244, s[20:23], s61 offen sc1
    v_add_u32 v245, v245, v246
    ds_read_b128 v[212:215], v245
    s_waitcnt lgkmcnt(0)
    v_perm_b32 v220, v213, v212, s77
    v_perm_b32 v221, v215, v214, s77
    v_perm_b32 v222, v213, v212, s78
    v_perm_b32 v223, v215, v214, s78
    s_add_u32 s61, s79, 262144
    buffer_store_dwordx4 v[220:223], v244, s[20:23], s61 offen sc1
    v_add_u32 v245, v245, v246
    ds_read_b128 v[208:211], v245
    s_waitcnt lgkmcnt(0)
    v_perm_b32 v216, v209, v208, s77
    v_perm_b32 v217, v211, v210, s77
    v_perm_b32 v218, v209, v208, s78
    v_perm_b32 v219, v211, v210, s78
    s_add_u32 s61, s79, 524288
    buffer_store_dwordx4 v[216:219], v244, s[20:23], s61 offen sc1
    v_add_u32 v245, v245, v246
    ds_read_b128 v[212:215], v245
    s_waitcnt lgkmcnt(0)
    v_perm_b32 v220, v213, v212, s77
    v_perm_b32 v221, v215, v214, s77
    v_perm_b32 v222, v213, v212, s78
    v_perm_b32 v223, v215, v214, s78
    s_add_u32 s61, s79, 786432
    buffer_store_dwordx4 v[220:223], v244, s[20:23], s61 offen sc1
    s_barrier
    v_add_u32 v245, v245, v246
    ds_read_b128 v[208:211], v245
    s_waitcnt lgkmcnt(0)
    v_perm_b32 v216, v209, v208, s77
    v_perm_b32 v217, v211, v210, s77
    v_perm_b32 v218, v209, v208, s78
    v_perm_b32 v219, v211, v210, s78
    s_add_u32 s61, s79, 1048576
    buffer_store_dwordx4 v[216:219], v244, s[20:23], s61 offen sc1
    v_add_u32 v245, v245, v246
    ds_read_b128 v[212:215], v245
    s_waitcnt lgkmcnt(0)
    v_perm_b32 v220, v213, v212, s77
    v_perm_b32 v221, v215, v214, s77
    v_perm_b32 v222, v213, v212, s78
    v_perm_b32 v223, v215, v214, s78
    s_add_u32 s61, s79, 1310720
    buffer_store_dwordx4 v[220:223], v244, s[20:23], s61 offen sc1
    v_add_u32 v245, v245, v246
    ds_read_b128 v[208:211], v245
    s_waitcnt lgkmcnt(0)
    v_perm_b32 v216, v209, v208, s77
    v_perm_b32 v217, v211, v210, s77
    v_perm_b32 v218, v209, v208, s78
    v_perm_b32 v219, v211, v210, s78
    s_add_u32 s61, s79, 1572864
    buffer_store_dwordx4 v[216:219], v244, s[20:23], s61 offen sc1
    v_add_u32 v245, v245, v246
    ds_read_b128 v[212:215], v245
    s_waitcnt lgkmcnt(0)
    v_perm_b32 v220, v213, v212, s77
    v_perm_b32 v221, v215, v214, s77
    v_perm_b32 v222, v213, v212, s78
    v_perm_b32 v223, v215, v214, s78
    s_add_u32 s61, s79, 1835008
    buffer_store_dwordx4 v[220:223], v244, s[20:23], s61 offen sc1
    s_barrier
    v_add_u32 v245, v245, v246
    ds_read_b128 v[208:211], v245
    s_waitcnt lgkmcnt(0)
    v_perm_b32 v216, v209, v208, s77
    v_perm_b32 v217, v211, v210, s77
    v_perm_b32 v218, v209, v208, s78
    v_perm_b32 v219, v211, v210, s78
    s_add_u32 s61, s79, 2097152
    buffer_store_dwordx4 v[216:219], v244, s[20:23], s61 offen sc1
    v_add_u32 v245, v245, v246
    ds_read_b128 v[212:215], v245
    s_waitcnt lgkmcnt(0)
    v_perm_b32 v220, v213, v212, s77
    v_perm_b32 v221, v215, v214, s77
    v_perm_b32 v222, v213, v212, s78
    v_perm_b32 v223, v215, v214, s78
    s_add_u32 s61, s79, 2359296
    buffer_store_dwordx4 v[220:223], v244, s[20:23], s61 offen sc1
    v_add_u32 v245, v245, v246
    ds_read_b128 v[208:211], v245
    s_waitcnt lgkmcnt(0)
    v_perm_b32 v216, v209, v208, s77
    v_perm_b32 v217, v211, v210, s77
    v_perm_b32 v218, v209, v208, s78
    v_perm_b32 v219, v211, v210, s78
    s_add_u32 s61, s79, 2621440
    buffer_store_dwordx4 v[216:219], v244, s[20:23], s61 offen sc1
    v_add_u32 v245, v245, v246
    ds_read_b128 v[212:215], v245
    s_waitcnt lgkmcnt(0)
    v_perm_b32 v220, v213, v212, s77
    v_perm_b32 v221, v215, v214, s77
    v_perm_b32 v222, v213, v212, s78
    v_perm_b32 v223, v215, v214, s78
    s_add_u32 s61, s79, 2883584
    buffer_store_dwordx4 v[220:223], v244, s[20:23], s61 offen sc1
    s_barrier
    v_add_u32 v245, v245, v246
    ds_read_b128 v[208:211], v245
    s_waitcnt lgkmcnt(0)
    v_perm_b32 v216, v209, v208, s77
    v_perm_b32 v217, v211, v210, s77
    v_perm_b32 v218, v209, v208, s78
    v_perm_b32 v219, v211, v210, s78
    s_add_u32 s61, s79, 3145728
    buffer_store_dwordx4 v[216:219], v244, s[20:23], s61 offen sc1
    v_add_u32 v245, v245, v246
    ds_read_b128 v[212:215], v245
    s_waitcnt lgkmcnt(0)
    v_perm_b32 v220, v213, v212, s77
    v_perm_b32 v221, v215, v214, s77
    v_perm_b32 v222, v213, v212, s78
    v_perm_b32 v223, v215, v214, s78
    s_add_u32 s61, s79, 3407872
    buffer_store_dwordx4 v[220:223], v244, s[20:23], s61 offen sc1
    v_add_u32 v245, v245, v246
    ds_read_b128 v[208:211], v245
    s_waitcnt lgkmcnt(0)
    v_perm_b32 v216, v209, v208, s77
    v_perm_b32 v217, v211, v210, s77
    v_perm_b32 v218, v209, v208, s78
    v_perm_b32 v219, v211, v210, s78
    s_add_u32 s61, s79, 3670016
    buffer_store_dwordx4 v[216:219], v244, s[20:23], s61 offen sc1
    v_add_u32 v245, v245, v246
    ds_read_b128 v[212:215], v245
    s_waitcnt lgkmcnt(0)
    v_perm_b32 v220, v213, v212, s77
    v_perm_b32 v221, v215, v214, s77
    v_perm_b32 v222, v213, v212, s78
    v_perm_b32 v223, v215, v214, s78
    s_add_u32 s61, s79, 3932160
    buffer_store_dwordx4 v[220:223], v244, s[20:23], s61 offen sc1
    s_barrier
    s_barrier
    s_barrier
    s_barrier
    s_waitcnt vmcnt(0)
    s_mov_b64 exec, 1
    v_mov_b32 v238, 1
    s_lshl_b32 s67, s6, 5
    s_add_u32 s67, s67, 12
    v_mov_b32 v239, s67
    buffer_atomic_add v238, v239, s[28:31], 0 offen
    s_mov_b64 exec, -1
    s_barrier
    s_barrier
    s_barrier
    s_barrier
    s_barrier
    s_barrier
    s_barrier
    s_barrier
    s_barrier
gated_mix__spectral_fnet__dense_activation_squared_relu__prompt_kernel_C2:
    v_lshrrev_b32 v2, 5, v1
    v_bfe_u32 v3, v1, 2, 2
    v_lshl_add_u32 v2, v2, 2, v3
    v_lshlrev_b32 v2, 9, v2
    v_bfe_u32 v3, v1, 4, 1
    v_lshlrev_b32 v3, 2, v3
    v_and_b32 v4, 3, v1
    v_add_u32 v3, v3, v4
    v_lshlrev_b32 v3, 6, v3
    s_lshl_b32 s60, s4, 4
    s_add_u32 s60, s60, 147456
    v_add3_u32 v8, v2, v3, s60
    ds_read_b64_tr_b16 v[40:41], v8 offset:0
    ds_read_b64_tr_b16 v[42:43], v8 offset:4096
    ds_read_b64_tr_b16 v[44:45], v8 offset:8192
    ds_read_b64_tr_b16 v[46:47], v8 offset:12288
    ds_read_b64_tr_b16 v[48:49], v8 offset:8
    ds_read_b64_tr_b16 v[50:51], v8 offset:4104
    ds_read_b64_tr_b16 v[52:53], v8 offset:8200
    ds_read_b64_tr_b16 v[54:55], v8 offset:12296
    v_and_b32 v2, 31, v1
    v_lshrrev_b32 v3, 5, v1
    v_mul_u32_u24 v4, 33, v2
    v_lshl_add_u32 v4, v3, 2, v4
    v_lshlrev_b32 v4, 3, v4
    s_mul_i32 s60, s4, 8448
    s_add_u32 s60, s60, 0
    v_add_u32 v10, s60, v4
    v_add_u32 v5, 31, v2
    v_and_b32 v5, 31, v5
    v_mul_u32_u24 v5, 33, v5
    v_add_u32 v5, 32, v5
    v_lshlrev_b32 v5, 3, v5
    v_add_u32 v14, s60, v5
    s_xor_b32 s61, s4, 2
    s_and_b32 s67, s4, 1
    s_or_b32 s67, s67, s5
    s_cmp_eq_u32 s67, 0
    s_cselect_b32 s61, s4, s61
    s_mul_i32 s61, s61, 8448
    s_add_u32 s61, s61, 0
    v_sub_u32 v5, 31, v2
    v_mul_u32_u24 v5, 33, v5
    v_lshlrev_b32 v4, 2, v3
    v_sub_u32 v5, v5, v4
    v_add_u32 v5, 5, v5
    v_lshlrev_b32 v5, 3, v5
    v_add_u32 v11, s61, v5
    v_lshlrev_b32 v12, 6, v2
    v_lshl_add_u32 v12, v3, 4, v12
    s_lshl_b32 s60, s4, 12
    s_add_u32 s60, s60, 147456
    v_add_u32 v12, s60, v12
    s_waitcnt lgkmcnt(0)
    v_mfma_f32_32x32x16_bf16 v[64:79], v[40:43], v[16:19], 0
    v_mfma_f32_32x32x16_bf16 v[80:95], v[48:51], v[16:19], 0
    v_mfma_f32_32x32x16_bf16 v[64:79], v[44:47], v[20:23], v[64:79]
    v_mfma_f32_32x32x16_bf16 v[80:95], v[52:55], v[20:23], v[80:95]
    v_mfma_f32_32x32x16_bf16 v[64:79], v[48:51], v[24:27], v[64:79]
    v_mfma_f32_32x32x16_bf16 v[80:95], v[40:43], v[32:35], v[80:95]
    v_mfma_f32_32x32x16_bf16 v[64:79], v[52:55], v[28:31], v[64:79]
    v_mfma_f32_32x32x16_bf16 v[80:95], v[44:47], v[36:39], v[80:95]
    s_nop 7
    s_nop 7
    v_pk_mul_f32 v[2:3], v[80:81], v[112:113]
    v_pk_mul_f32 v[4:5], v[64:65], v[112:113]
    v_pk_fma_f32 v[64:65], v[64:65], v[96:97], v[2:3]
    v_pk_fma_f32 v[80:81], v[80:81], v[96:97], v[4:5] neg_lo:[0,0,1] neg_hi:[0,0,1]
    v_cvt_pk_bf16_f32 v40, v64, v65
    v_cvt_pk_bf16_f32 v48, v80, v81
    v_pk_mul_f32 v[2:3], v[82:83], v[114:115]
    v_pk_mul_f32 v[4:5], v[66:67], v[114:115]
    v_pk_fma_f32 v[66:67], v[66:67], v[98:99], v[2:3]
    v_pk_fma_f32 v[82:83], v[82:83], v[98:99], v[4:5] neg_lo:[0,0,1] neg_hi:[0,0,1]
    v_cvt_pk_bf16_f32 v41, v66, v67
    v_cvt_pk_bf16_f32 v49, v82, v83
    v_pk_mul_f32 v[2:3], v[84:85], v[116:117]
    v_pk_mul_f32 v[4:5], v[68:69], v[116:117]
    v_pk_fma_f32 v[68:69], v[68:69], v[100:101], v[2:3]
    v_pk_fma_f32 v[84:85], v[84:85], v[100:101], v[4:5] neg_lo:[0,0,1] neg_hi:[0,0,1]
    v_cvt_pk_bf16_f32 v42, v68, v69
    v_cvt_pk_bf16_f32 v50, v84, v85
    v_pk_mul_f32 v[2:3], v[86:87], v[118:119]
    v_pk_mul_f32 v[4:5], v[70:71], v[118:119]
    v_pk_fma_f32 v[70:71], v[70:71], v[102:103], v[2:3]
    v_pk_fma_f32 v[86:87], v[86:87], v[102:103], v[4:5] neg_lo:[0,0,1] neg_hi:[0,0,1]
    v_cvt_pk_bf16_f32 v43, v70, v71
    v_cvt_pk_bf16_f32 v51, v86, v87
    v_pk_mul_f32 v[2:3], v[88:89], v[120:121]
    v_pk_mul_f32 v[4:5], v[72:73], v[120:121]
    v_pk_fma_f32 v[72:73], v[72:73], v[104:105], v[2:3]
    v_pk_fma_f32 v[88:89], v[88:89], v[104:105], v[4:5] neg_lo:[0,0,1] neg_hi:[0,0,1]
    v_cvt_pk_bf16_f32 v44, v72, v73
    v_cvt_pk_bf16_f32 v52, v88, v89
    v_pk_mul_f32 v[2:3], v[90:91], v[122:123]
    v_pk_mul_f32 v[4:5], v[74:75], v[122:123]
    v_pk_fma_f32 v[74:75], v[74:75], v[106:107], v[2:3]
    v_pk_fma_f32 v[90:91], v[90:91], v[106:107], v[4:5] neg_lo:[0,0,1] neg_hi:[0,0,1]
    v_cvt_pk_bf16_f32 v45, v74, v75
    v_cvt_pk_bf16_f32 v53, v90, v91
    v_pk_mul_f32 v[2:3], v[92:93], v[124:125]
    v_pk_mul_f32 v[4:5], v[76:77], v[124:125]
    v_pk_fma_f32 v[76:77], v[76:77], v[108:109], v[2:3]
    v_pk_fma_f32 v[92:93], v[92:93], v[108:109], v[4:5] neg_lo:[0,0,1] neg_hi:[0,0,1]
    v_cvt_pk_bf16_f32 v46, v76, v77
    v_cvt_pk_bf16_f32 v54, v92, v93
    v_pk_mul_f32 v[2:3], v[94:95], v[126:127]
    v_pk_mul_f32 v[4:5], v[78:79], v[126:127]
    v_pk_fma_f32 v[78:79], v[78:79], v[110:111], v[2:3]
    v_pk_fma_f32 v[94:95], v[94:95], v[110:111], v[4:5] neg_lo:[0,0,1] neg_hi:[0,0,1]
    v_cvt_pk_bf16_f32 v47, v78, v79
    v_cvt_pk_bf16_f32 v55, v94, v95
    s_nop 1
    v_mfma_f32_32x32x16_bf16 v[64:79], v[40:43], v[16:19], 0
    v_mfma_f32_32x32x16_bf16 v[80:95], v[48:51], v[16:19], 0
    v_mfma_f32_32x32x16_bf16 v[64:79], v[44:47], v[20:23], v[64:79]
    v_mfma_f32_32x32x16_bf16 v[80:95], v[52:55], v[20:23], v[80:95]
    v_mfma_f32_32x32x16_bf16 v[64:79], v[48:51], v[24:27], v[64:79]
    v_mfma_f32_32x32x16_bf16 v[80:95], v[40:43], v[32:35], v[80:95]
    v_mfma_f32_32x32x16_bf16 v[64:79], v[52:55], v[28:31], v[64:79]
    v_mfma_f32_32x32x16_bf16 v[80:95], v[44:47], v[36:39], v[80:95]
    s_nop 7
    s_nop 7
    ds_write2_b32 v10, v64, v80 offset0:0 offset1:1
    ds_write2_b32 v10, v65, v81 offset0:2 offset1:3
    ds_write2_b32 v10, v66, v82 offset0:4 offset1:5
    ds_write2_b32 v10, v67, v83 offset0:6 offset1:7
    ds_write2_b32 v10, v68, v84 offset0:16 offset1:17
    ds_write2_b32 v10, v69, v85 offset0:18 offset1:19
    ds_write2_b32 v10, v70, v86 offset0:20 offset1:21
    ds_write2_b32 v10, v71, v87 offset0:22 offset1:23
    ds_write2_b32 v10, v72, v88 offset0:32 offset1:33
    ds_write2_b32 v10, v73, v89 offset0:34 offset1:35
    ds_write2_b32 v10, v74, v90 offset0:36 offset1:37
    ds_write2_b32 v10, v75, v91 offset0:38 offset1:39
    ds_write2_b32 v10, v76, v92 offset0:48 offset1:49
    ds_write2_b32 v10, v77, v93 offset0:50 offset1:51
    ds_write2_b32 v10, v78, v94 offset0:52 offset1:53
    ds_write2_b32 v10, v79, v95 offset0:54 offset1:55
    s_mov_b32 exec_hi, 0
    ds_write2_b32 v14, v64, v80 offset0:0 offset1:1
    s_mov_b64 exec, -1
    s_waitcnt lgkmcnt(0)
    s_barrier
    s_cmp_ge_u32 s3, 6
    s_cbranch_scc1 gated_mix__spectral_fnet__dense_activation_squared_relu__prompt_kernel_w2h
    s_add_u32 s68, s72, 2
    s_cmp_ge_u32 s68, 28
    s_cselect_b32 s67, 28, 0
    s_sub_u32 s68, s68, s67
    s_lshl_b32 s67, s68, 17
    s_add_u32 s67, s67, s71
    s_add_u32 m0, s65, 114688
    s_nop 0
    buffer_load_dwordx4 v220, s[16:19], s67 offen offset:0 lds
    buffer_load_dwordx4 v221, s[16:19], s67 offen offset:1024 lds
    buffer_load_dwordx4 v222, s[16:19], s67 offen offset:2048 lds
    buffer_load_dwordx4 v223, s[16:19], s67 offen offset:3072 lds
    s_add_u32 m0, s65, 118784
    s_add_u32 s67, s67, 32768
    buffer_load_dwordx4 v220, s[16:19], s67 offen offset:0 lds
    buffer_load_dwordx4 v221, s[16:19], s67 offen offset:1024 lds
    buffer_load_dwordx4 v222, s[16:19], s67 offen offset:2048 lds
    buffer_load_dwordx4 v223, s[16:19], s67 offen offset:3072 lds
    s_add_u32 s68, s72, 3
    s_cmp_ge_u32 s68, 28
    s_cselect_b32 s67, 28, 0
    s_sub_u32 s68, s68, s67
    s_lshl_b32 s67, s68, 17
    s_add_u32 s67, s67, s71
    s_add_u32 m0, s65, 131072
    s_nop 0
    buffer_load_dwordx4 v220, s[16:19], s67 offen offset:0 lds
    buffer_load_dwordx4 v221, s[16:19], s67 offen offset:1024 lds
    buffer_load_dwordx4 v222, s[16:19], s67 offen offset:2048 lds
    buffer_load_dwordx4 v223, s[16:19], s67 offen offset:3072 lds
    s_add_u32 m0, s65, 135168
    s_add_u32 s67, s67, 32768
    buffer_load_dwordx4 v220, s[16:19], s67 offen offset:0 lds
    buffer_load_dwordx4 v221, s[16:19], s67 offen offset:1024 lds
    buffer_load_dwordx4 v222, s[16:19], s67 offen offset:2048 lds
    buffer_load_dwordx4 v223, s[16:19], s67 offen offset:3072 lds
gated_mix__spectral_fnet__dense_activation_squared_relu__prompt_kernel_w2h:
    s_cmp_lg_u32 s3, 7
    s_cbranch_scc1 gated_mix__spectral_fnet__dense_activation_squared_relu__prompt_kernel_nofl
    s_mov_b64 exec, 0x200
    s_cmp_eq_u32 s54, 0
    s_cbranch_scc0 gated_mix__spectral_fnet__dense_activation_squared_relu__prompt_kernel_fl1
    buffer_store_dword v237, v236, s[20:23], 0 offen
    s_branch gated_mix__spectral_fnet__dense_activation_squared_relu__prompt_kernel_fl2
gated_mix__spectral_fnet__dense_activation_squared_relu__prompt_kernel_fl1:
    buffer_store_dword v237, v236, s[20:23], 0 offen sc1
gated_mix__spectral_fnet__dense_activation_squared_relu__prompt_kernel_fl2:
    s_mov_b64 exec, -1
gated_mix__spectral_fnet__dense_activation_squared_relu__prompt_kernel_nofl:
    ds_read2_b32 v[128:129], v11 offset0:54 offset1:52
    ds_read2_b32 v[144:145], v11 offset0:55 offset1:53
    ds_read2_b32 v[130:131], v11 offset0:50 offset1:48
    ds_read2_b32 v[146:147], v11 offset0:51 offset1:49
    ds_read2_b32 v[132:133], v11 offset0:38 offset1:36
    ds_read2_b32 v[148:149], v11 offset0:39 offset1:37
    ds_read2_b32 v[134:135], v11 offset0:34 offset1:32
    ds_read2_b32 v[150:151], v11 offset0:35 offset1:33
    ds_read2_b32 v[136:137], v11 offset0:22 offset1:20
    ds_read2_b32 v[152:153], v11 offset0:23 offset1:21
    ds_read2_b32 v[138:139], v11 offset0:18 offset1:16
    ds_read2_b32 v[154:155], v11 offset0:19 offset1:17
    ds_read2_b32 v[140:141], v11 offset0:6 offset1:4
    ds_read2_b32 v[156:157], v11 offset0:7 offset1:5
    ds_read2_b32 v[142:143], v11 offset0:2 offset1:0
    ds_read2_b32 v[158:159], v11 offset0:3 offset1:1
    s_waitcnt lgkmcnt(0)
    s_barrier
    s_cmp_ge_u32 s3, 6
    s_cbranch_scc1 gated_mix__spectral_fnet__dense_activation_squared_relu__prompt_kernel_nox2
    s_mov_b64 exec, 0xff
    s_mov_b32 s76, 200000
gated_mix__spectral_fnet__dense_activation_squared_relu__prompt_kernel_hpoll:
    buffer_load_dword v238, v236, s[20:23], 0 offen sc1
    s_waitcnt vmcnt(0)
    v_cmp_ne_u32 vcc, v238, v237
    s_nop 4
    s_cbranch_vccz gated_mix__spectral_fnet__dense_activation_squared_relu__prompt_kernel_hpoll_d
    s_sub_u32 s76, s76, 1
    s_cmp_eq_u32 s76, 0
    s_cbranch_scc1 gated_mix__spectral_fnet__dense_activation_squared_relu__prompt_kernel_hpoll_d
    s_sleep 0
    s_branch gated_mix__spectral_fnet__dense_activation_squared_relu__prompt_kernel_hpoll
gated_mix__spectral_fnet__dense_activation_squared_relu__prompt_kernel_hpoll_d:
    s_mov_b64 exec, -1
    s_add_u32 s68, s72, 0
    s_cmp_ge_u32 s68, 28
    s_cselect_b32 s67, 28, 0
    s_sub_u32 s68, s68, s67
    s_lshl_b32 s67, s68, 14
    s_add_u32 s67, s67, s62
    s_add_u32 m0, s65, 0
    s_nop 0
    buffer_load_dwordx4 v235, s[20:23], s67 offen offset:0 sc1 lds
    buffer_load_dwordx4 v235, s[20:23], s67 offen offset:1024 sc1 lds
    buffer_load_dwordx4 v235, s[20:23], s67 offen offset:2048 sc1 lds
    buffer_load_dwordx4 v235, s[20:23], s67 offen offset:3072 sc1 lds
    s_add_u32 m0, s65, 4096
    s_add_u32 s67, s67, 4096
    buffer_load_dwordx4 v235, s[20:23], s67 offen offset:0 sc1 lds
    buffer_load_dwordx4 v235, s[20:23], s67 offen offset:1024 sc1 lds
    buffer_load_dwordx4 v235, s[20:23], s67 offen offset:2048 sc1 lds
    buffer_load_dwordx4 v235, s[20:23], s67 offen offset:3072 sc1 lds
    s_add_u32 s68, s72, 1
    s_cmp_ge_u32 s68, 28
    s_cselect_b32 s67, 28, 0
    s_sub_u32 s68, s68, s67
    s_lshl_b32 s67, s68, 14
    s_add_u32 s67, s67, s62
    s_add_u32 m0, s65, 16384
    s_nop 0
    buffer_load_dwordx4 v235, s[20:23], s67 offen offset:0 sc1 lds
    buffer_load_dwordx4 v235, s[20:23], s67 offen offset:1024 sc1 lds
    buffer_load_dwordx4 v235, s[20:23], s67 offen offset:2048 sc1 lds
    buffer_load_dwordx4 v235, s[20:23], s67 offen offset:3072 sc1 lds
    s_add_u32 m0, s65, 20480
    s_add_u32 s67, s67, 4096
    buffer_load_dwordx4 v235, s[20:23], s67 offen offset:0 sc1 lds
    buffer_load_dwordx4 v235, s[20:23], s67 offen offset:1024 sc1 lds
    buffer_load_dwordx4 v235, s[20:23], s67 offen offset:2048 sc1 lds
    buffer_load_dwordx4 v235, s[20:23], s67 offen offset:3072 sc1 lds
    s_add_u32 s68, s72, 2
    s_cmp_ge_u32 s68, 28
    s_cselect_b32 s67, 28, 0
    s_sub_u32 s68, s68, s67
    s_lshl_b32 s67, s68, 14
    s_add_u32 s67, s67, s62
    s_add_u32 m0, s65, 32768
    s_nop 0
    buffer_load_dwordx4 v235, s[20:23], s67 offen offset:0 sc1 lds
    buffer_load_dwordx4 v235, s[20:23], s67 offen offset:1024 sc1 lds
    buffer_load_dwordx4 v235, s[20:23], s67 offen offset:2048 sc1 lds
    buffer_load_dwordx4 v235, s[20:23], s67 offen offset:3072 sc1 lds
    s_add_u32 m0, s65, 36864
    s_add_u32 s67, s67, 4096
    buffer_load_dwordx4 v235, s[20:23], s67 offen offset:0 sc1 lds
    buffer_load_dwordx4 v235, s[20:23], s67 offen offset:1024 sc1 lds
    buffer_load_dwordx4 v235, s[20:23], s67 offen offset:2048 sc1 lds
    buffer_load_dwordx4 v235, s[20:23], s67 offen offset:3072 sc1 lds
    s_add_u32 s68, s72, 3
    s_cmp_ge_u32 s68, 28
    s_cselect_b32 s67, 28, 0
    s_sub_u32 s68, s68, s67
    s_lshl_b32 s67, s68, 14
    s_add_u32 s67, s67, s62
    s_add_u32 m0, s65, 49152
    s_nop 0
    buffer_load_dwordx4 v235, s[20:23], s67 offen offset:0 sc1 lds
    buffer_load_dwordx4 v235, s[20:23], s67 offen offset:1024 sc1 lds
    buffer_load_dwordx4 v235, s[20:23], s67 offen offset:2048 sc1 lds
    buffer_load_dwordx4 v235, s[20:23], s67 offen offset:3072 sc1 lds
    s_add_u32 m0, s65, 53248
    s_add_u32 s67, s67, 4096
    buffer_load_dwordx4 v235, s[20:23], s67 offen offset:0 sc1 lds
    buffer_load_dwordx4 v235, s[20:23], s67 offen offset:1024 sc1 lds
    buffer_load_dwordx4 v235, s[20:23], s67 offen offset:2048 sc1 lds
    buffer_load_dwordx4 v235, s[20:23], s67 offen offset:3072 sc1 lds
    s_add_u32 s68, s72, 4
    s_cmp_ge_u32 s68, 28
    s_cselect_b32 s67, 28, 0
    s_sub_u32 s68, s68, s67
    s_lshl_b32 s67, s68, 14
    s_add_u32 s67, s67, s62
    s_add_u32 m0, s65, 65536
    s_nop 0
    buffer_load_dwordx4 v235, s[20:23], s67 offen offset:0 sc1 lds
    buffer_load_dwordx4 v235, s[20:23], s67 offen offset:1024 sc1 lds
    buffer_load_dwordx4 v235, s[20:23], s67 offen offset:2048 sc1 lds
    buffer_load_dwordx4 v235, s[20:23], s67 offen offset:3072 sc1 lds
    s_add_u32 m0, s65, 69632
    s_add_u32 s67, s67, 4096
    buffer_load_dwordx4 v235, s[20:23], s67 offen offset:0 sc1 lds
    buffer_load_dwordx4 v235, s[20:23], s67 offen offset:1024 sc1 lds
    buffer_load_dwordx4 v235, s[20:23], s67 offen offset:2048 sc1 lds
    buffer_load_dwordx4 v235, s[20:23], s67 offen offset:3072 sc1 lds
gated_mix__spectral_fnet__dense_activation_squared_relu__prompt_kernel_nox2:
    v_pk_add_f32 v[2:3], v[64:65], v[128:129] neg_lo:[0,1] neg_hi:[0,1]
    v_pk_add_f32 v[64:65], v[64:65], v[128:129]
    v_pk_add_f32 v[80:81], v[80:81], v[144:145]
    v_pk_mul_f32 v[2:3], v[2:3], v[192:193]
    v_pk_fma_f32 v[2:3], v[80:81], v[176:177], v[2:3] neg_lo:[0,0,1] neg_hi:[0,0,1]
    v_pk_add_f32 v[80:81], v[64:65], v[2:3] neg_lo:[0,1] neg_hi:[0,1]
    v_pk_add_f32 v[64:65], v[64:65], v[2:3]
    v_pk_add_f32 v[2:3], v[66:67], v[130:131] neg_lo:[0,1] neg_hi:[0,1]
    v_pk_add_f32 v[66:67], v[66:67], v[130:131]
    v_pk_add_f32 v[82:83], v[82:83], v[146:147]
    v_pk_mul_f32 v[2:3], v[2:3], v[194:195]
    v_pk_fma_f32 v[2:3], v[82:83], v[178:179], v[2:3] neg_lo:[0,0,1] neg_hi:[0,0,1]
    v_pk_add_f32 v[82:83], v[66:67], v[2:3] neg_lo:[0,1] neg_hi:[0,1]
    v_pk_add_f32 v[66:67], v[66:67], v[2:3]
    v_pk_add_f32 v[2:3], v[68:69], v[132:133] neg_lo:[0,1] neg_hi:[0,1]
    v_pk_add_f32 v[68:69], v[68:69], v[132:133]
    v_pk_add_f32 v[84:85], v[84:85], v[148:149]
    v_pk_mul_f32 v[2:3], v[2:3], v[196:197]
    v_pk_fma_f32 v[2:3], v[84:85], v[180:181], v[2:3] neg_lo:[0,0,1] neg_hi:[0,0,1]
    v_pk_add_f32 v[84:85], v[68:69], v[2:3] neg_lo:[0,1] neg_hi:[0,1]
    v_pk_add_f32 v[68:69], v[68:69], v[2:3]
    v_pk_add_f32 v[2:3], v[70:71], v[134:135] neg_lo:[0,1] neg_hi:[0,1]
    v_pk_add_f32 v[70:71], v[70:71], v[134:135]
    v_pk_add_f32 v[86:87], v[86:87], v[150:151]
    v_pk_mul_f32 v[2:3], v[2:3], v[198:199]
    v_pk_fma_f32 v[2:3], v[86:87], v[182:183], v[2:3] neg_lo:[0,0,1] neg_hi:[0,0,1]
    v_pk_add_f32 v[86:87], v[70:71], v[2:3] neg_lo:[0,1] neg_hi:[0,1]
    v_pk_add_f32 v[70:71], v[70:71], v[2:3]
    v_pk_add_f32 v[2:3], v[72:73], v[136:137] neg_lo:[0,1] neg_hi:[0,1]
    v_pk_add_f32 v[72:73], v[72:73], v[136:137]
    v_pk_add_f32 v[88:89], v[88:89], v[152:153]
    v_pk_mul_f32 v[2:3], v[2:3], v[200:201]
    v_pk_fma_f32 v[2:3], v[88:89], v[184:185], v[2:3] neg_lo:[0,0,1] neg_hi:[0,0,1]
    v_pk_add_f32 v[88:89], v[72:73], v[2:3] neg_lo:[0,1] neg_hi:[0,1]
    v_pk_add_f32 v[72:73], v[72:73], v[2:3]
    v_pk_add_f32 v[2:3], v[74:75], v[138:139] neg_lo:[0,1] neg_hi:[0,1]
    v_pk_add_f32 v[74:75], v[74:75], v[138:139]
    v_pk_add_f32 v[90:91], v[90:91], v[154:155]
    v_pk_mul_f32 v[2:3], v[2:3], v[202:203]
    v_pk_fma_f32 v[2:3], v[90:91], v[186:187], v[2:3] neg_lo:[0,0,1] neg_hi:[0,0,1]
    v_pk_add_f32 v[90:91], v[74:75], v[2:3] neg_lo:[0,1] neg_hi:[0,1]
    v_pk_add_f32 v[74:75], v[74:75], v[2:3]
    v_pk_add_f32 v[2:3], v[76:77], v[140:141] neg_lo:[0,1] neg_hi:[0,1]
    v_pk_add_f32 v[76:77], v[76:77], v[140:141]
    v_pk_add_f32 v[92:93], v[92:93], v[156:157]
    v_pk_mul_f32 v[2:3], v[2:3], v[204:205]
    v_pk_fma_f32 v[2:3], v[92:93], v[188:189], v[2:3] neg_lo:[0,0,1] neg_hi:[0,0,1]
    v_pk_add_f32 v[92:93], v[76:77], v[2:3] neg_lo:[0,1] neg_hi:[0,1]
    v_pk_add_f32 v[76:77], v[76:77], v[2:3]
    v_pk_add_f32 v[2:3], v[78:79], v[142:143] neg_lo:[0,1] neg_hi:[0,1]
    v_pk_add_f32 v[78:79], v[78:79], v[142:143]
    v_pk_add_f32 v[94:95], v[94:95], v[158:159]
    v_pk_mul_f32 v[2:3], v[2:3], v[206:207]
    v_pk_fma_f32 v[2:3], v[94:95], v[190:191], v[2:3] neg_lo:[0,0,1] neg_hi:[0,0,1]
    v_pk_add_f32 v[94:95], v[78:79], v[2:3] neg_lo:[0,1] neg_hi:[0,1]
    v_pk_add_f32 v[78:79], v[78:79], v[2:3]
    v_cvt_pk_bf16_f32 v40, v64, v65
    v_cvt_pk_bf16_f32 v41, v66, v67
    v_cvt_pk_bf16_f32 v42, v68, v69
    v_cvt_pk_bf16_f32 v43, v70, v71
    s_nop 1
    v_permlane32_swap_b32 v40, v42
    v_permlane32_swap_b32 v41, v43
    s_nop 0
    ds_write_b128 v12, v[40:43] offset:0
    v_cvt_pk_bf16_f32 v44, v72, v73
    v_cvt_pk_bf16_f32 v45, v74, v75
    v_cvt_pk_bf16_f32 v46, v76, v77
    v_cvt_pk_bf16_f32 v47, v78, v79
    s_nop 1
    v_permlane32_swap_b32 v44, v46
    v_permlane32_swap_b32 v45, v47
    s_nop 0
    ds_write_b128 v12, v[44:47] offset:32
    v_cvt_pk_bf16_f32 v48, v80, v81
    v_cvt_pk_bf16_f32 v49, v82, v83
    v_cvt_pk_bf16_f32 v50, v84, v85
    v_cvt_pk_bf16_f32 v51, v86, v87
    s_nop 1
    v_permlane32_swap_b32 v48, v50
    v_permlane32_swap_b32 v49, v51
    s_nop 0
    ds_write_b128 v12, v[48:51] offset:2048
    v_cvt_pk_bf16_f32 v52, v88, v89
    v_cvt_pk_bf16_f32 v53, v90, v91
    v_cvt_pk_bf16_f32 v54, v92, v93
    v_cvt_pk_bf16_f32 v55, v94, v95
    s_nop 1
    v_permlane32_swap_b32 v52, v54
    v_permlane32_swap_b32 v53, v55
    s_nop 0
    ds_write_b128 v12, v[52:55] offset:2080
    s_cmp_eq_u32 s3, 7
    s_cbranch_scc1 gated_mix__spectral_fnet__dense_activation_squared_relu__prompt_kernel_S2
    s_cmp_eq_u32 s3, 6
    s_cbranch_scc1 gated_mix__spectral_fnet__dense_activation_squared_relu__prompt_kernel_I2
    s_waitcnt vmcnt(32) lgkmcnt(0)
    s_barrier
    s_waitcnt vmcnt(24)
    s_barrier
    s_add_u32 s68, s72, 5
    s_cmp_ge_u32 s68, 28
    s_cselect_b32 s67, 28, 0
    s_sub_u32 s68, s68, s67
    s_lshl_b32 s67, s68, 14
    s_add_u32 s67, s67, s62
    s_add_u32 m0, s65, 0
    s_nop 0
    buffer_load_dwordx4 v235, s[20:23], s67 offen offset:0 sc1 lds
    buffer_load_dwordx4 v235, s[20:23], s67 offen offset:1024 sc1 lds
    buffer_load_dwordx4 v235, s[20:23], s67 offen offset:2048 sc1 lds
    buffer_load_dwordx4 v235, s[20:23], s67 offen offset:3072 sc1 lds
    s_add_u32 m0, s65, 4096
    s_add_u32 s67, s67, 4096
    buffer_load_dwordx4 v235, s[20:23], s67 offen offset:0 sc1 lds
    buffer_load_dwordx4 v235, s[20:23], s67 offen offset:1024 sc1 lds
    buffer_load_dwordx4 v235, s[20:23], s67 offen offset:2048 sc1 lds
    buffer_load_dwordx4 v235, s[20:23], s67 offen offset:3072 sc1 lds
    s_add_u32 s68, s72, 4
    s_cmp_ge_u32 s68, 28
    s_cselect_b32 s67, 28, 0
    s_sub_u32 s68, s68, s67
    s_lshl_b32 s67, s68, 17
    s_add_u32 s67, s67, s71
    s_add_u32 m0, s65, 81920
    s_nop 0
    buffer_load_dwordx4 v220, s[16:19], s67 offen offset:0 lds
    buffer_load_dwordx4 v221, s[16:19], s67 offen offset:1024 lds
    buffer_load_dwordx4 v222, s[16:19], s67 offen offset:2048 lds
    buffer_load_dwordx4 v223, s[16:19], s67 offen offset:3072 lds
    s_add_u32 m0, s65, 86016
    s_add_u32 s67, s67, 32768
    buffer_load_dwordx4 v220, s[16:19], s67 offen offset:0 lds
    buffer_load_dwordx4 v221, s[16:19], s67 offen offset:1024 lds
    buffer_load_dwordx4 v222, s[16:19], s67 offen offset:2048 lds
    buffer_load_dwordx4 v223, s[16:19], s67 offen offset:3072 lds
    s_waitcnt vmcnt(32)
    s_barrier
    s_add_u32 s68, s72, 6
    s_cmp_ge_u32 s68, 28
    s_cselect_b32 s67, 28, 0
    s_sub_u32 s68, s68, s67
    s_lshl_b32 s67, s68, 14
    s_add_u32 s67, s67, s62
    s_add_u32 m0, s65, 16384
    s_nop 0
    buffer_load_dwordx4 v235, s[20:23], s67 offen offset:0 sc1 lds
    buffer_load_dwordx4 v235, s[20:23], s67 offen offset:1024 sc1 lds
    buffer_load_dwordx4 v235, s[20:23], s67 offen offset:2048 sc1 lds
    buffer_load_dwordx4 v235, s[20:23], s67 offen offset:3072 sc1 lds
    s_add_u32 m0, s65, 20480
    s_add_u32 s67, s67, 4096
    buffer_load_dwordx4 v235, s[20:23], s67 offen offset:0 sc1 lds
    buffer_load_dwordx4 v235, s[20:23], s67 offen offset:1024 sc1 lds
    buffer_load_dwordx4 v235, s[20:23], s67 offen offset:2048 sc1 lds
    buffer_load_dwordx4 v235, s[20:23], s67 offen offset:3072 sc1 lds
    s_add_u32 s68, s72, 5
    s_cmp_ge_u32 s68, 28
    s_cselect_b32 s67, 28, 0
    s_sub_u32 s68, s68, s67
    s_lshl_b32 s67, s68, 17
    s_add_u32 s67, s67, s71
    s_add_u32 m0, s65, 98304
    s_nop 0
    buffer_load_dwordx4 v220, s[16:19], s67 offen offset:0 lds
    buffer_load_dwordx4 v221, s[16:19], s67 offen offset:1024 lds
    buffer_load_dwordx4 v222, s[16:19], s67 offen offset:2048 lds
    buffer_load_dwordx4 v223, s[16:19], s67 offen offset:3072 lds
    s_add_u32 m0, s65, 102400
    s_add_u32 s67, s67, 32768
    buffer_load_dwordx4 v220, s[16:19], s67 offen offset:0 lds
    buffer_load_dwordx4 v221, s[16:19], s67 offen offset:1024 lds
    buffer_load_dwordx4 v222, s[16:19], s67 offen offset:2048 lds
    buffer_load_dwordx4 v223, s[16:19], s67 offen offset:3072 lds
    s_waitcnt vmcnt(40)
    s_barrier
    s_add_u32 s68, s72, 7
    s_cmp_ge_u32 s68, 28
    s_cselect_b32 s67, 28, 0
    s_sub_u32 s68, s68, s67
    s_lshl_b32 s67, s68, 14
    s_add_u32 s67, s67, s62
    s_add_u32 m0, s65, 32768
    s_nop 0
    buffer_load_dwordx4 v235, s[20:23], s67 offen offset:0 sc1 lds
    buffer_load_dwordx4 v235, s[20:23], s67 offen offset:1024 sc1 lds
    buffer_load_dwordx4 v235, s[20:23], s67 offen offset:2048 sc1 lds
    buffer_load_dwordx4 v235, s[20:23], s67 offen offset:3072 sc1 lds
    s_add_u32 m0, s65, 36864
    s_add_u32 s67, s67, 4096
    buffer_load_dwordx4 v235, s[20:23], s67 offen offset:0 sc1 lds
    buffer_load_dwordx4 v235, s[20:23], s67 offen offset:1024 sc1 lds
    buffer_load_dwordx4 v235, s[20:23], s67 offen offset:2048 sc1 lds
    buffer_load_dwordx4 v235, s[20:23], s67 offen offset:3072 sc1 lds
    s_add_u32 s68, s72, 6
    s_cmp_ge_u32 s68, 28
    s_cselect_b32 s67, 28, 0
    s_sub_u32 s68, s68, s67
    s_lshl_b32 s67, s68, 17
    s_add_u32 s67, s67, s71
    s_add_u32 m0, s65, 114688
    s_nop 0
    buffer_load_dwordx4 v220, s[16:19], s67 offen offset:0 lds
    buffer_load_dwordx4 v221, s[16:19], s67 offen offset:1024 lds
    buffer_load_dwordx4 v222, s[16:19], s67 offen offset:2048 lds
    buffer_load_dwordx4 v223, s[16:19], s67 offen offset:3072 lds
    s_add_u32 m0, s65, 118784
    s_add_u32 s67, s67, 32768
    buffer_load_dwordx4 v220, s[16:19], s67 offen offset:0 lds
    buffer_load_dwordx4 v221, s[16:19], s67 offen offset:1024 lds
    buffer_load_dwordx4 v222, s[16:19], s67 offen offset:2048 lds
    buffer_load_dwordx4 v223, s[16:19], s67 offen offset:3072 lds
    s_waitcnt vmcnt(32)
    s_barrier
    s_add_u32 s68, s72, 8
    s_cmp_ge_u32 s68, 28
    s_cselect_b32 s67, 28, 0
    s_sub_u32 s68, s68, s67
    s_lshl_b32 s67, s68, 14
    s_add_u32 s67, s67, s62
    s_add_u32 m0, s65, 49152
    s_nop 0
    buffer_load_dwordx4 v235, s[20:23], s67 offen offset:0 sc1 lds
    buffer_load_dwordx4 v235, s[20:23], s67 offen offset:1024 sc1 lds
    buffer_load_dwordx4 v235, s[20:23], s67 offen offset:2048 sc1 lds
    buffer_load_dwordx4 v235, s[20:23], s67 offen offset:3072 sc1 lds
    s_add_u32 m0, s65, 53248
    s_add_u32 s67, s67, 4096
    buffer_load_dwordx4 v235, s[20:23], s67 offen offset:0 sc1 lds
    buffer_load_dwordx4 v235, s[20:23], s67 offen offset:1024 sc1 lds
    buffer_load_dwordx4 v235, s[20:23], s67 offen offset:2048 sc1 lds
    buffer_load_dwordx4 v235, s[20:23], s67 offen offset:3072 sc1 lds
    s_add_u32 s68, s72, 7
    s_cmp_ge_u32 s68, 28
    s_cselect_b32 s67, 28, 0
    s_sub_u32 s68, s68, s67
    s_lshl_b32 s67, s68, 17
    s_add_u32 s67, s67, s71
    s_add_u32 m0, s65, 131072
    s_nop 0
    buffer_load_dwordx4 v220, s[16:19], s67 offen offset:0 lds
    buffer_load_dwordx4 v221, s[16:19], s67 offen offset:1024 lds
    buffer_load_dwordx4 v222, s[16:19], s67 offen offset:2048 lds
    buffer_load_dwordx4 v223, s[16:19], s67 offen offset:3072 lds
    s_add_u32 m0, s65, 135168
    s_add_u32 s67, s67, 32768
    buffer_load_dwordx4 v220, s[16:19], s67 offen offset:0 lds
    buffer_load_dwordx4 v221, s[16:19], s67 offen offset:1024 lds
    buffer_load_dwordx4 v222, s[16:19], s67 offen offset:2048 lds
    buffer_load_dwordx4 v223, s[16:19], s67 offen offset:3072 lds
    s_waitcnt vmcnt(32)
    s_barrier
    s_add_u32 s68, s72, 9
    s_cmp_ge_u32 s68, 28
    s_cselect_b32 s67, 28, 0
    s_sub_u32 s68, s68, s67
    s_lshl_b32 s67, s68, 14
    s_add_u32 s67, s67, s62
    s_add_u32 m0, s65, 65536
    s_nop 0
    buffer_load_dwordx4 v235, s[20:23], s67 offen offset:0 sc1 lds
    buffer_load_dwordx4 v235, s[20:23], s67 offen offset:1024 sc1 lds
    buffer_load_dwordx4 v235, s[20:23], s67 offen offset:2048 sc1 lds
    buffer_load_dwordx4 v235, s[20:23], s67 offen offset:3072 sc1 lds
    s_add_u32 m0, s65, 69632
    s_add_u32 s67, s67, 4096
    buffer_load_dwordx4 v235, s[20:23], s67 offen offset:0 sc1 lds
    buffer_load_dwordx4 v235, s[20:23], s67 offen offset:1024 sc1 lds
    buffer_load_dwordx4 v235, s[20:23], s67 offen offset:2048 sc1 lds
    buffer_load_dwordx4 v235, s[20:23], s67 offen offset:3072 sc1 lds
    s_add_u32 s68, s72, 8
    s_cmp_ge_u32 s68, 28
    s_cselect_b32 s67, 28, 0
    s_sub_u32 s68, s68, s67
    s_lshl_b32 s67, s68, 17
    s_add_u32 s67, s67, s71
    s_add_u32 m0, s65, 81920
    s_nop 0
    buffer_load_dwordx4 v220, s[16:19], s67 offen offset:0 lds
    buffer_load_dwordx4 v221, s[16:19], s67 offen offset:1024 lds
    buffer_load_dwordx4 v222, s[16:19], s67 offen offset:2048 lds
    buffer_load_dwordx4 v223, s[16:19], s67 offen offset:3072 lds
    s_add_u32 m0, s65, 86016
    s_add_u32 s67, s67, 32768
    buffer_load_dwordx4 v220, s[16:19], s67 offen offset:0 lds
    buffer_load_dwordx4 v221, s[16:19], s67 offen offset:1024 lds
    buffer_load_dwordx4 v222, s[16:19], s67 offen offset:2048 lds
    buffer_load_dwordx4 v223, s[16:19], s67 offen offset:3072 lds
    s_waitcnt vmcnt(32)
    s_barrier
    s_add_u32 s68, s72, 10
    s_cmp_ge_u32 s68, 28
    s_cselect_b32 s67, 28, 0
    s_sub_u32 s68, s68, s67
    s_lshl_b32 s67, s68, 14
    s_add_u32 s67, s67, s62
    s_add_u32 m0, s65, 0
    s_nop 0
    buffer_load_dwordx4 v235, s[20:23], s67 offen offset:0 sc1 lds
    buffer_load_dwordx4 v235, s[20:23], s67 offen offset:1024 sc1 lds
    buffer_load_dwordx4 v235, s[20:23], s67 offen offset:2048 sc1 lds
    buffer_load_dwordx4 v235, s[20:23], s67 offen offset:3072 sc1 lds
    s_add_u32 m0, s65, 4096
    s_add_u32 s67, s67, 4096
    buffer_load_dwordx4 v235, s[20:23], s67 offen offset:0 sc1 lds
    buffer_load_dwordx4 v235, s[20:23], s67 offen offset:1024 sc1 lds
    buffer_load_dwordx4 v235, s[20:23], s67 offen offset:2048 sc1 lds
    buffer_load_dwordx4 v235, s[20:23], s67 offen offset:3072 sc1 lds
    s_add_u32 s68, s72, 9
    s_cmp_ge_u32 s68, 28
    s_cselect_b32 s67, 28, 0
    s_sub_u32 s68, s68, s67
    s_lshl_b32 s67, s68, 17
    s_add_u32 s67, s67, s71
    s_add_u32 m0, s65, 98304
    s_nop 0
    buffer_load_dwordx4 v220, s[16:19], s67 offen offset:0 lds
    buffer_load_dwordx4 v221, s[16:19], s67 offen offset:1024 lds
    buffer_load_dwordx4 v222, s[16:19], s67 offen offset:2048 lds
    buffer_load_dwordx4 v223, s[16:19], s67 offen offset:3072 lds
    s_add_u32 m0, s65, 102400
    s_add_u32 s67, s67, 32768
    buffer_load_dwordx4 v220, s[16:19], s67 offen offset:0 lds
    buffer_load_dwordx4 v221, s[16:19], s67 offen offset:1024 lds
    buffer_load_dwordx4 v222, s[16:19], s67 offen offset:2048 lds
    buffer_load_dwordx4 v223, s[16:19], s67 offen offset:3072 lds
    s_waitcnt vmcnt(32)
    s_barrier
    s_add_u32 s68, s72, 11
    s_cmp_ge_u32 s68, 28
    s_cselect_b32 s67, 28, 0
    s_sub_u32 s68, s68, s67
    s_lshl_b32 s67, s68, 14
    s_add_u32 s67, s67, s62
    s_add_u32 m0, s65, 16384
    s_nop 0
    buffer_load_dwordx4 v235, s[20:23], s67 offen offset:0 sc1 lds
    buffer_load_dwordx4 v235, s[20:23], s67 offen offset:1024 sc1 lds
    buffer_load_dwordx4 v235, s[20:23], s67 offen offset:2048 sc1 lds
    buffer_load_dwordx4 v235, s[20:23], s67 offen offset:3072 sc1 lds
    s_add_u32 m0, s65, 20480
    s_add_u32 s67, s67, 4096
    buffer_load_dwordx4 v235, s[20:23], s67 offen offset:0 sc1 lds
    buffer_load_dwordx4 v235, s[20:23], s67 offen offset:1024 sc1 lds
    buffer_load_dwordx4 v235, s[20:23], s67 offen offset:2048 sc1 lds
    buffer_load_dwordx4 v235, s[20:23], s67 offen offset:3072 sc1 lds
    s_add_u32 s68, s72, 10
    s_cmp_ge_u32 s68, 28
    s_cselect_b32 s67, 28, 0
    s_sub_u32 s68, s68, s67
    s_lshl_b32 s67, s68, 17
    s_add_u32 s67, s67, s71
    s_add_u32 m0, s65, 114688
    s_nop 0
    buffer_load_dwordx4 v220, s[16:19], s67 offen offset:0 lds
    buffer_load_dwordx4 v221, s[16:19], s67 offen offset:1024 lds
    buffer_load_dwordx4 v222, s[16:19], s67 offen offset:2048 lds
    buffer_load_dwordx4 v223, s[16:19], s67 offen offset:3072 lds
    s_add_u32 m0, s65, 118784
    s_add_u32 s67, s67, 32768
    buffer_load_dwordx4 v220, s[16:19], s67 offen offset:0 lds
    buffer_load_dwordx4 v221, s[16:19], s67 offen offset:1024 lds
    buffer_load_dwordx4 v222, s[16:19], s67 offen offset:2048 lds
    buffer_load_dwordx4 v223, s[16:19], s67 offen offset:3072 lds
    s_waitcnt vmcnt(32)
    s_barrier
    s_add_u32 s68, s72, 12
    s_cmp_ge_u32 s68, 28
    s_cselect_b32 s67, 28, 0
    s_sub_u32 s68, s68, s67
    s_lshl_b32 s67, s68, 14
    s_add_u32 s67, s67, s62
    s_add_u32 m0, s65, 32768
    s_nop 0
    buffer_load_dwordx4 v235, s[20:23], s67 offen offset:0 sc1 lds
    buffer_load_dwordx4 v235, s[20:23], s67 offen offset:1024 sc1 lds
    buffer_load_dwordx4 v235, s[20:23], s67 offen offset:2048 sc1 lds
    buffer_load_dwordx4 v235, s[20:23], s67 offen offset:3072 sc1 lds
    s_add_u32 m0, s65, 36864
    s_add_u32 s67, s67, 4096
    buffer_load_dwordx4 v235, s[20:23], s67 offen offset:0 sc1 lds
    buffer_load_dwordx4 v235, s[20:23], s67 offen offset:1024 sc1 lds
    buffer_load_dwordx4 v235, s[20:23], s67 offen offset:2048 sc1 lds
    buffer_load_dwordx4 v235, s[20:23], s67 offen offset:3072 sc1 lds
    s_add_u32 s68, s72, 11
    s_cmp_ge_u32 s68, 28
    s_cselect_b32 s67, 28, 0
    s_sub_u32 s68, s68, s67
    s_lshl_b32 s67, s68, 17
    s_add_u32 s67, s67, s71
    s_add_u32 m0, s65, 131072
    s_nop 0
    buffer_load_dwordx4 v220, s[16:19], s67 offen offset:0 lds
    buffer_load_dwordx4 v221, s[16:19], s67 offen offset:1024 lds
    buffer_load_dwordx4 v222, s[16:19], s67 offen offset:2048 lds
    buffer_load_dwordx4 v223, s[16:19], s67 offen offset:3072 lds
    s_add_u32 m0, s65, 135168
    s_add_u32 s67, s67, 32768
    buffer_load_dwordx4 v220, s[16:19], s67 offen offset:0 lds
    buffer_load_dwordx4 v221, s[16:19], s67 offen offset:1024 lds
    buffer_load_dwordx4 v222, s[16:19], s67 offen offset:2048 lds
    buffer_load_dwordx4 v223, s[16:19], s67 offen offset:3072 lds
    s_waitcnt vmcnt(32)
    s_barrier
    s_add_u32 s68, s72, 13
    s_cmp_ge_u32 s68, 28
    s_cselect_b32 s67, 28, 0
    s_sub_u32 s68, s68, s67
    s_lshl_b32 s67, s68, 14
    s_add_u32 s67, s67, s62
    s_add_u32 m0, s65, 49152
    s_nop 0
    buffer_load_dwordx4 v235, s[20:23], s67 offen offset:0 sc1 lds
    buffer_load_dwordx4 v235, s[20:23], s67 offen offset:1024 sc1 lds
    buffer_load_dwordx4 v235, s[20:23], s67 offen offset:2048 sc1 lds
    buffer_load_dwordx4 v235, s[20:23], s67 offen offset:3072 sc1 lds
    s_add_u32 m0, s65, 53248
    s_add_u32 s67, s67, 4096
    buffer_load_dwordx4 v235, s[20:23], s67 offen offset:0 sc1 lds
    buffer_load_dwordx4 v235, s[20:23], s67 offen offset:1024 sc1 lds
    buffer_load_dwordx4 v235, s[20:23], s67 offen offset:2048 sc1 lds
    buffer_load_dwordx4 v235, s[20:23], s67 offen offset:3072 sc1 lds
    s_add_u32 s68, s72, 12
    s_cmp_ge_u32 s68, 28
    s_cselect_b32 s67, 28, 0
    s_sub_u32 s68, s68, s67
    s_lshl_b32 s67, s68, 17
    s_add_u32 s67, s67, s71
    s_add_u32 m0, s65, 81920
    s_nop 0
    buffer_load_dwordx4 v220, s[16:19], s67 offen offset:0 lds
    buffer_load_dwordx4 v221, s[16:19], s67 offen offset:1024 lds
    buffer_load_dwordx4 v222, s[16:19], s67 offen offset:2048 lds
    buffer_load_dwordx4 v223, s[16:19], s67 offen offset:3072 lds
    s_add_u32 m0, s65, 86016
    s_add_u32 s67, s67, 32768
    buffer_load_dwordx4 v220, s[16:19], s67 offen offset:0 lds
    buffer_load_dwordx4 v221, s[16:19], s67 offen offset:1024 lds
    buffer_load_dwordx4 v222, s[16:19], s67 offen offset:2048 lds
    buffer_load_dwordx4 v223, s[16:19], s67 offen offset:3072 lds
    s_waitcnt vmcnt(32)
    s_barrier
    s_add_u32 s68, s72, 14
    s_cmp_ge_u32 s68, 28
    s_cselect_b32 s67, 28, 0
    s_sub_u32 s68, s68, s67
    s_lshl_b32 s67, s68, 14
    s_add_u32 s67, s67, s62
    s_add_u32 m0, s65, 65536
    s_nop 0
    buffer_load_dwordx4 v235, s[20:23], s67 offen offset:0 sc1 lds
    buffer_load_dwordx4 v235, s[20:23], s67 offen offset:1024 sc1 lds
    buffer_load_dwordx4 v235, s[20:23], s67 offen offset:2048 sc1 lds
    buffer_load_dwordx4 v235, s[20:23], s67 offen offset:3072 sc1 lds
    s_add_u32 m0, s65, 69632
    s_add_u32 s67, s67, 4096
    buffer_load_dwordx4 v235, s[20:23], s67 offen offset:0 sc1 lds
    buffer_load_dwordx4 v235, s[20:23], s67 offen offset:1024 sc1 lds
    buffer_load_dwordx4 v235, s[20:23], s67 offen offset:2048 sc1 lds
    buffer_load_dwordx4 v235, s[20:23], s67 offen offset:3072 sc1 lds
    s_add_u32 s68, s72, 13
    s_cmp_ge_u32 s68, 28
    s_cselect_b32 s67, 28, 0
    s_sub_u32 s68, s68, s67
    s_lshl_b32 s67, s68, 17
    s_add_u32 s67, s67, s71
    s_add_u32 m0, s65, 98304
    s_nop 0
    buffer_load_dwordx4 v220, s[16:19], s67 offen offset:0 lds
    buffer_load_dwordx4 v221, s[16:19], s67 offen offset:1024 lds
    buffer_load_dwordx4 v222, s[16:19], s67 offen offset:2048 lds
    buffer_load_dwordx4 v223, s[16:19], s67 offen offset:3072 lds
    s_add_u32 m0, s65, 102400
    s_add_u32 s67, s67, 32768
    buffer_load_dwordx4 v220, s[16:19], s67 offen offset:0 lds
    buffer_load_dwordx4 v221, s[16:19], s67 offen offset:1024 lds
    buffer_load_dwordx4 v222, s[16:19], s67 offen offset:2048 lds
    buffer_load_dwordx4 v223, s[16:19], s67 offen offset:3072 lds
    s_waitcnt vmcnt(32)
    s_barrier
    s_add_u32 s68, s72, 15
    s_cmp_ge_u32 s68, 28
    s_cselect_b32 s67, 28, 0
    s_sub_u32 s68, s68, s67
    s_lshl_b32 s67, s68, 14
    s_add_u32 s67, s67, s62
    s_add_u32 m0, s65, 0
    s_nop 0
    buffer_load_dwordx4 v235, s[20:23], s67 offen offset:0 sc1 lds
    buffer_load_dwordx4 v235, s[20:23], s67 offen offset:1024 sc1 lds
    buffer_load_dwordx4 v235, s[20:23], s67 offen offset:2048 sc1 lds
    buffer_load_dwordx4 v235, s[20:23], s67 offen offset:3072 sc1 lds
    s_add_u32 m0, s65, 4096
    s_add_u32 s67, s67, 4096
    buffer_load_dwordx4 v235, s[20:23], s67 offen offset:0 sc1 lds
    buffer_load_dwordx4 v235, s[20:23], s67 offen offset:1024 sc1 lds
    buffer_load_dwordx4 v235, s[20:23], s67 offen offset:2048 sc1 lds
    buffer_load_dwordx4 v235, s[20:23], s67 offen offset:3072 sc1 lds
    s_add_u32 s68, s72, 14
    s_cmp_ge_u32 s68, 28
    s_cselect_b32 s67, 28, 0
    s_sub_u32 s68, s68, s67
    s_lshl_b32 s67, s68, 17
    s_add_u32 s67, s67, s71
    s_add_u32 m0, s65, 114688
    s_nop 0
    buffer_load_dwordx4 v220, s[16:19], s67 offen offset:0 lds
    buffer_load_dwordx4 v221, s[16:19], s67 offen offset:1024 lds
    buffer_load_dwordx4 v222, s[16:19], s67 offen offset:2048 lds
    buffer_load_dwordx4 v223, s[16:19], s67 offen offset:3072 lds
    s_add_u32 m0, s65, 118784
    s_add_u32 s67, s67, 32768
    buffer_load_dwordx4 v220, s[16:19], s67 offen offset:0 lds
    buffer_load_dwordx4 v221, s[16:19], s67 offen offset:1024 lds
    buffer_load_dwordx4 v222, s[16:19], s67 offen offset:2048 lds
    buffer_load_dwordx4 v223, s[16:19], s67 offen offset:3072 lds
    s_waitcnt vmcnt(32)
    s_barrier
    s_add_u32 s68, s72, 16
    s_cmp_ge_u32 s68, 28
    s_cselect_b32 s67, 28, 0
    s_sub_u32 s68, s68, s67
    s_lshl_b32 s67, s68, 14
    s_add_u32 s67, s67, s62
    s_add_u32 m0, s65, 16384
    s_nop 0
    buffer_load_dwordx4 v235, s[20:23], s67 offen offset:0 sc1 lds
    buffer_load_dwordx4 v235, s[20:23], s67 offen offset:1024 sc1 lds
    buffer_load_dwordx4 v235, s[20:23], s67 offen offset:2048 sc1 lds
    buffer_load_dwordx4 v235, s[20:23], s67 offen offset:3072 sc1 lds
    s_add_u32 m0, s65, 20480
    s_add_u32 s67, s67, 4096
    buffer_load_dwordx4 v235, s[20:23], s67 offen offset:0 sc1 lds
    buffer_load_dwordx4 v235, s[20:23], s67 offen offset:1024 sc1 lds
    buffer_load_dwordx4 v235, s[20:23], s67 offen offset:2048 sc1 lds
    buffer_load_dwordx4 v235, s[20:23], s67 offen offset:3072 sc1 lds
    s_add_u32 s68, s72, 15
    s_cmp_ge_u32 s68, 28
    s_cselect_b32 s67, 28, 0
    s_sub_u32 s68, s68, s67
    s_lshl_b32 s67, s68, 17
    s_add_u32 s67, s67, s71
    s_add_u32 m0, s65, 131072
    s_nop 0
    buffer_load_dwordx4 v220, s[16:19], s67 offen offset:0 lds
    buffer_load_dwordx4 v221, s[16:19], s67 offen offset:1024 lds
    buffer_load_dwordx4 v222, s[16:19], s67 offen offset:2048 lds
    buffer_load_dwordx4 v223, s[16:19], s67 offen offset:3072 lds
    s_add_u32 m0, s65, 135168
    s_add_u32 s67, s67, 32768
    buffer_load_dwordx4 v220, s[16:19], s67 offen offset:0 lds
    buffer_load_dwordx4 v221, s[16:19], s67 offen offset:1024 lds
    buffer_load_dwordx4 v222, s[16:19], s67 offen offset:2048 lds
    buffer_load_dwordx4 v223, s[16:19], s67 offen offset:3072 lds
    s_waitcnt vmcnt(32)
    s_barrier
    s_add_u32 s68, s72, 17
    s_cmp_ge_u32 s68, 28
    s_cselect_b32 s67, 28, 0
    s_sub_u32 s68, s68, s67
    s_lshl_b32 s67, s68, 14
    s_add_u32 s67, s67, s62
    s_add_u32 m0, s65, 32768
    s_nop 0
    buffer_load_dwordx4 v235, s[20:23], s67 offen offset:0 sc1 lds
    buffer_load_dwordx4 v235, s[20:23], s67 offen offset:1024 sc1 lds
    buffer_load_dwordx4 v235, s[20:23], s67 offen offset:2048 sc1 lds
    buffer_load_dwordx4 v235, s[20:23], s67 offen offset:3072 sc1 lds
    s_add_u32 m0, s65, 36864
    s_add_u32 s67, s67, 4096
    buffer_load_dwordx4 v235, s[20:23], s67 offen offset:0 sc1 lds
    buffer_load_dwordx4 v235, s[20:23], s67 offen offset:1024 sc1 lds
    buffer_load_dwordx4 v235, s[20:23], s67 offen offset:2048 sc1 lds
    buffer_load_dwordx4 v235, s[20:23], s67 offen offset:3072 sc1 lds
    s_add_u32 s68, s72, 16
    s_cmp_ge_u32 s68, 28
    s_cselect_b32 s67, 28, 0
    s_sub_u32 s68, s68, s67
    s_lshl_b32 s67, s68, 17
    s_add_u32 s67, s67, s71
    s_add_u32 m0, s65, 81920
    s_nop 0
    buffer_load_dwordx4 v220, s[16:19], s67 offen offset:0 lds
    buffer_load_dwordx4 v221, s[16:19], s67 offen offset:1024 lds
    buffer_load_dwordx4 v222, s[16:19], s67 offen offset:2048 lds
    buffer_load_dwordx4 v223, s[16:19], s67 offen offset:3072 lds
    s_add_u32 m0, s65, 86016
    s_add_u32 s67, s67, 32768
    buffer_load_dwordx4 v220, s[16:19], s67 offen offset:0 lds
    buffer_load_dwordx4 v221, s[16:19], s67 offen offset:1024 lds
    buffer_load_dwordx4 v222, s[16:19], s67 offen offset:2048 lds
    buffer_load_dwordx4 v223, s[16:19], s67 offen offset:3072 lds
    s_waitcnt vmcnt(32)
    s_barrier
    s_add_u32 s68, s72, 18
    s_cmp_ge_u32 s68, 28
    s_cselect_b32 s67, 28, 0
    s_sub_u32 s68, s68, s67
    s_lshl_b32 s67, s68, 14
    s_add_u32 s67, s67, s62
    s_add_u32 m0, s65, 49152
    s_nop 0
    buffer_load_dwordx4 v235, s[20:23], s67 offen offset:0 sc1 lds
    buffer_load_dwordx4 v235, s[20:23], s67 offen offset:1024 sc1 lds
    buffer_load_dwordx4 v235, s[20:23], s67 offen offset:2048 sc1 lds
    buffer_load_dwordx4 v235, s[20:23], s67 offen offset:3072 sc1 lds
    s_add_u32 m0, s65, 53248
    s_add_u32 s67, s67, 4096
    buffer_load_dwordx4 v235, s[20:23], s67 offen offset:0 sc1 lds
    buffer_load_dwordx4 v235, s[20:23], s67 offen offset:1024 sc1 lds
    buffer_load_dwordx4 v235, s[20:23], s67 offen offset:2048 sc1 lds
    buffer_load_dwordx4 v235, s[20:23], s67 offen offset:3072 sc1 lds
    s_add_u32 s68, s72, 17
    s_cmp_ge_u32 s68, 28
    s_cselect_b32 s67, 28, 0
    s_sub_u32 s68, s68, s67
    s_lshl_b32 s67, s68, 17
    s_add_u32 s67, s67, s71
    s_add_u32 m0, s65, 98304
    s_nop 0
    buffer_load_dwordx4 v220, s[16:19], s67 offen offset:0 lds
    buffer_load_dwordx4 v221, s[16:19], s67 offen offset:1024 lds
    buffer_load_dwordx4 v222, s[16:19], s67 offen offset:2048 lds
    buffer_load_dwordx4 v223, s[16:19], s67 offen offset:3072 lds
    s_add_u32 m0, s65, 102400
    s_add_u32 s67, s67, 32768
    buffer_load_dwordx4 v220, s[16:19], s67 offen offset:0 lds
    buffer_load_dwordx4 v221, s[16:19], s67 offen offset:1024 lds
    buffer_load_dwordx4 v222, s[16:19], s67 offen offset:2048 lds
    buffer_load_dwordx4 v223, s[16:19], s67 offen offset:3072 lds
    s_waitcnt vmcnt(32)
    s_barrier
    s_add_u32 s68, s72, 19
    s_cmp_ge_u32 s68, 28
    s_cselect_b32 s67, 28, 0
    s_sub_u32 s68, s68, s67
    s_lshl_b32 s67, s68, 14
    s_add_u32 s67, s67, s62
    s_add_u32 m0, s65, 65536
    s_nop 0
    buffer_load_dwordx4 v235, s[20:23], s67 offen offset:0 sc1 lds
    buffer_load_dwordx4 v235, s[20:23], s67 offen offset:1024 sc1 lds
    buffer_load_dwordx4 v235, s[20:23], s67 offen offset:2048 sc1 lds
    buffer_load_dwordx4 v235, s[20:23], s67 offen offset:3072 sc1 lds
    s_add_u32 m0, s65, 69632
    s_add_u32 s67, s67, 4096
    buffer_load_dwordx4 v235, s[20:23], s67 offen offset:0 sc1 lds
    buffer_load_dwordx4 v235, s[20:23], s67 offen offset:1024 sc1 lds
    buffer_load_dwordx4 v235, s[20:23], s67 offen offset:2048 sc1 lds
    buffer_load_dwordx4 v235, s[20:23], s67 offen offset:3072 sc1 lds
    s_add_u32 s68, s72, 18
    s_cmp_ge_u32 s68, 28
    s_cselect_b32 s67, 28, 0
    s_sub_u32 s68, s68, s67
    s_lshl_b32 s67, s68, 17
    s_add_u32 s67, s67, s71
    s_add_u32 m0, s65, 114688
    s_nop 0
    buffer_load_dwordx4 v220, s[16:19], s67 offen offset:0 lds
    buffer_load_dwordx4 v221, s[16:19], s67 offen offset:1024 lds
    buffer_load_dwordx4 v222, s[16:19], s67 offen offset:2048 lds
    buffer_load_dwordx4 v223, s[16:19], s67 offen offset:3072 lds
    s_add_u32 m0, s65, 118784
    s_add_u32 s67, s67, 32768
    buffer_load_dwordx4 v220, s[16:19], s67 offen offset:0 lds
    buffer_load_dwordx4 v221, s[16:19], s67 offen offset:1024 lds
    buffer_load_dwordx4 v222, s[16:19], s67 offen offset:2048 lds
    buffer_load_dwordx4 v223, s[16:19], s67 offen offset:3072 lds
    s_waitcnt vmcnt(32)
    s_barrier
    s_add_u32 s68, s72, 20
    s_cmp_ge_u32 s68, 28
    s_cselect_b32 s67, 28, 0
    s_sub_u32 s68, s68, s67
    s_lshl_b32 s67, s68, 14
    s_add_u32 s67, s67, s62
    s_add_u32 m0, s65, 0
    s_nop 0
    buffer_load_dwordx4 v235, s[20:23], s67 offen offset:0 sc1 lds
    buffer_load_dwordx4 v235, s[20:23], s67 offen offset:1024 sc1 lds
    buffer_load_dwordx4 v235, s[20:23], s67 offen offset:2048 sc1 lds
    buffer_load_dwordx4 v235, s[20:23], s67 offen offset:3072 sc1 lds
    s_add_u32 m0, s65, 4096
    s_add_u32 s67, s67, 4096
    buffer_load_dwordx4 v235, s[20:23], s67 offen offset:0 sc1 lds
    buffer_load_dwordx4 v235, s[20:23], s67 offen offset:1024 sc1 lds
    buffer_load_dwordx4 v235, s[20:23], s67 offen offset:2048 sc1 lds
    buffer_load_dwordx4 v235, s[20:23], s67 offen offset:3072 sc1 lds
    s_add_u32 s68, s72, 19
    s_cmp_ge_u32 s68, 28
    s_cselect_b32 s67, 28, 0
    s_sub_u32 s68, s68, s67
    s_lshl_b32 s67, s68, 17
    s_add_u32 s67, s67, s71
    s_add_u32 m0, s65, 131072
    s_nop 0
    buffer_load_dwordx4 v220, s[16:19], s67 offen offset:0 lds
    buffer_load_dwordx4 v221, s[16:19], s67 offen offset:1024 lds
    buffer_load_dwordx4 v222, s[16:19], s67 offen offset:2048 lds
    buffer_load_dwordx4 v223, s[16:19], s67 offen offset:3072 lds
    s_add_u32 m0, s65, 135168
    s_add_u32 s67, s67, 32768
    buffer_load_dwordx4 v220, s[16:19], s67 offen offset:0 lds
    buffer_load_dwordx4 v221, s[16:19], s67 offen offset:1024 lds
    buffer_load_dwordx4 v222, s[16:19], s67 offen offset:2048 lds
    buffer_load_dwordx4 v223, s[16:19], s67 offen offset:3072 lds
    s_waitcnt vmcnt(32)
    s_barrier
    s_add_u32 s68, s72, 21
    s_cmp_ge_u32 s68, 28
    s_cselect_b32 s67, 28, 0
    s_sub_u32 s68, s68, s67
    s_lshl_b32 s67, s68, 14
    s_add_u32 s67, s67, s62
    s_add_u32 m0, s65, 16384
    s_nop 0
    buffer_load_dwordx4 v235, s[20:23], s67 offen offset:0 sc1 lds
    buffer_load_dwordx4 v235, s[20:23], s67 offen offset:1024 sc1 lds
    buffer_load_dwordx4 v235, s[20:23], s67 offen offset:2048 sc1 lds
    buffer_load_dwordx4 v235, s[20:23], s67 offen offset:3072 sc1 lds
    s_add_u32 m0, s65, 20480
    s_add_u32 s67, s67, 4096
    buffer_load_dwordx4 v235, s[20:23], s67 offen offset:0 sc1 lds
    buffer_load_dwordx4 v235, s[20:23], s67 offen offset:1024 sc1 lds
    buffer_load_dwordx4 v235, s[20:23], s67 offen offset:2048 sc1 lds
    buffer_load_dwordx4 v235, s[20:23], s67 offen offset:3072 sc1 lds
    s_add_u32 s68, s72, 20
    s_cmp_ge_u32 s68, 28
    s_cselect_b32 s67, 28, 0
    s_sub_u32 s68, s68, s67
    s_lshl_b32 s67, s68, 17
    s_add_u32 s67, s67, s71
    s_add_u32 m0, s65, 81920
    s_nop 0
    buffer_load_dwordx4 v220, s[16:19], s67 offen offset:0 lds
    buffer_load_dwordx4 v221, s[16:19], s67 offen offset:1024 lds
    buffer_load_dwordx4 v222, s[16:19], s67 offen offset:2048 lds
    buffer_load_dwordx4 v223, s[16:19], s67 offen offset:3072 lds
    s_add_u32 m0, s65, 86016
    s_add_u32 s67, s67, 32768
    buffer_load_dwordx4 v220, s[16:19], s67 offen offset:0 lds
    buffer_load_dwordx4 v221, s[16:19], s67 offen offset:1024 lds
    buffer_load_dwordx4 v222, s[16:19], s67 offen offset:2048 lds
    buffer_load_dwordx4 v223, s[16:19], s67 offen offset:3072 lds
    s_waitcnt vmcnt(32)
    s_barrier
    s_add_u32 s68, s72, 22
    s_cmp_ge_u32 s68, 28
    s_cselect_b32 s67, 28, 0
    s_sub_u32 s68, s68, s67
    s_lshl_b32 s67, s68, 14
    s_add_u32 s67, s67, s62
    s_add_u32 m0, s65, 32768
    s_nop 0
    buffer_load_dwordx4 v235, s[20:23], s67 offen offset:0 sc1 lds
    buffer_load_dwordx4 v235, s[20:23], s67 offen offset:1024 sc1 lds
    buffer_load_dwordx4 v235, s[20:23], s67 offen offset:2048 sc1 lds
    buffer_load_dwordx4 v235, s[20:23], s67 offen offset:3072 sc1 lds
    s_add_u32 m0, s65, 36864
    s_add_u32 s67, s67, 4096
    buffer_load_dwordx4 v235, s[20:23], s67 offen offset:0 sc1 lds
    buffer_load_dwordx4 v235, s[20:23], s67 offen offset:1024 sc1 lds
    buffer_load_dwordx4 v235, s[20:23], s67 offen offset:2048 sc1 lds
    buffer_load_dwordx4 v235, s[20:23], s67 offen offset:3072 sc1 lds
    s_add_u32 s68, s72, 21
    s_cmp_ge_u32 s68, 28
    s_cselect_b32 s67, 28, 0
    s_sub_u32 s68, s68, s67
    s_lshl_b32 s67, s68, 17
    s_add_u32 s67, s67, s71
    s_add_u32 m0, s65, 98304
    s_nop 0
    buffer_load_dwordx4 v220, s[16:19], s67 offen offset:0 lds
    buffer_load_dwordx4 v221, s[16:19], s67 offen offset:1024 lds
    buffer_load_dwordx4 v222, s[16:19], s67 offen offset:2048 lds
    buffer_load_dwordx4 v223, s[16:19], s67 offen offset:3072 lds
    s_add_u32 m0, s65, 102400
    s_add_u32 s67, s67, 32768
    buffer_load_dwordx4 v220, s[16:19], s67 offen offset:0 lds
    buffer_load_dwordx4 v221, s[16:19], s67 offen offset:1024 lds
    buffer_load_dwordx4 v222, s[16:19], s67 offen offset:2048 lds
    buffer_load_dwordx4 v223, s[16:19], s67 offen offset:3072 lds
    s_waitcnt vmcnt(32)
    s_barrier
    s_add_u32 s68, s72, 23
    s_cmp_ge_u32 s68, 28
    s_cselect_b32 s67, 28, 0
    s_sub_u32 s68, s68, s67
    s_lshl_b32 s67, s68, 14
    s_add_u32 s67, s67, s62
    s_add_u32 m0, s65, 49152
    s_nop 0
    buffer_load_dwordx4 v235, s[20:23], s67 offen offset:0 sc1 lds
    buffer_load_dwordx4 v235, s[20:23], s67 offen offset:1024 sc1 lds
    buffer_load_dwordx4 v235, s[20:23], s67 offen offset:2048 sc1 lds
    buffer_load_dwordx4 v235, s[20:23], s67 offen offset:3072 sc1 lds
    s_add_u32 m0, s65, 53248
    s_add_u32 s67, s67, 4096
    buffer_load_dwordx4 v235, s[20:23], s67 offen offset:0 sc1 lds
    buffer_load_dwordx4 v235, s[20:23], s67 offen offset:1024 sc1 lds
    buffer_load_dwordx4 v235, s[20:23], s67 offen offset:2048 sc1 lds
    buffer_load_dwordx4 v235, s[20:23], s67 offen offset:3072 sc1 lds
    s_add_u32 s68, s72, 22
    s_cmp_ge_u32 s68, 28
    s_cselect_b32 s67, 28, 0
    s_sub_u32 s68, s68, s67
    s_lshl_b32 s67, s68, 17
    s_add_u32 s67, s67, s71
    s_add_u32 m0, s65, 114688
    s_nop 0
    buffer_load_dwordx4 v220, s[16:19], s67 offen offset:0 lds
    buffer_load_dwordx4 v221, s[16:19], s67 offen offset:1024 lds
    buffer_load_dwordx4 v222, s[16:19], s67 offen offset:2048 lds
    buffer_load_dwordx4 v223, s[16:19], s67 offen offset:3072 lds
    s_add_u32 m0, s65, 118784
    s_add_u32 s67, s67, 32768
    buffer_load_dwordx4 v220, s[16:19], s67 offen offset:0 lds
    buffer_load_dwordx4 v221, s[16:19], s67 offen offset:1024 lds
    buffer_load_dwordx4 v222, s[16:19], s67 offen offset:2048 lds
    buffer_load_dwordx4 v223, s[16:19], s67 offen offset:3072 lds
    s_waitcnt vmcnt(32)
    s_barrier
    s_add_u32 s68, s72, 24
    s_cmp_ge_u32 s68, 28
    s_cselect_b32 s67, 28, 0
    s_sub_u32 s68, s68, s67
    s_lshl_b32 s67, s68, 14
    s_add_u32 s67, s67, s62
    s_add_u32 m0, s65, 65536
    s_nop 0
    buffer_load_dwordx4 v235, s[20:23], s67 offen offset:0 sc1 lds
    buffer_load_dwordx4 v235, s[20:23], s67 offen offset:1024 sc1 lds
    buffer_load_dwordx4 v235, s[20:23], s67 offen offset:2048 sc1 lds
    buffer_load_dwordx4 v235, s[20:23], s67 offen offset:3072 sc1 lds
    s_add_u32 m0, s65, 69632
    s_add_u32 s67, s67, 4096
    buffer_load_dwordx4 v235, s[20:23], s67 offen offset:0 sc1 lds
    buffer_load_dwordx4 v235, s[20:23], s67 offen offset:1024 sc1 lds
    buffer_load_dwordx4 v235, s[20:23], s67 offen offset:2048 sc1 lds
    buffer_load_dwordx4 v235, s[20:23], s67 offen offset:3072 sc1 lds
    s_add_u32 s68, s72, 23
    s_cmp_ge_u32 s68, 28
    s_cselect_b32 s67, 28, 0
    s_sub_u32 s68, s68, s67
    s_lshl_b32 s67, s68, 17
    s_add_u32 s67, s67, s71
    s_add_u32 m0, s65, 131072
    s_nop 0
    buffer_load_dwordx4 v220, s[16:19], s67 offen offset:0 lds
    buffer_load_dwordx4 v221, s[16:19], s67 offen offset:1024 lds
    buffer_load_dwordx4 v222, s[16:19], s67 offen offset:2048 lds
    buffer_load_dwordx4 v223, s[16:19], s67 offen offset:3072 lds
    s_add_u32 m0, s65, 135168
    s_add_u32 s67, s67, 32768
    buffer_load_dwordx4 v220, s[16:19], s67 offen offset:0 lds
    buffer_load_dwordx4 v221, s[16:19], s67 offen offset:1024 lds
    buffer_load_dwordx4 v222, s[16:19], s67 offen offset:2048 lds
    buffer_load_dwordx4 v223, s[16:19], s67 offen offset:3072 lds
    s_waitcnt vmcnt(32)
    s_barrier
    s_add_u32 s68, s72, 25
    s_cmp_ge_u32 s68, 28
    s_cselect_b32 s67, 28, 0
    s_sub_u32 s68, s68, s67
    s_lshl_b32 s67, s68, 14
    s_add_u32 s67, s67, s62
    s_add_u32 m0, s65, 0
    s_nop 0
    buffer_load_dwordx4 v235, s[20:23], s67 offen offset:0 sc1 lds
    buffer_load_dwordx4 v235, s[20:23], s67 offen offset:1024 sc1 lds
    buffer_load_dwordx4 v235, s[20:23], s67 offen offset:2048 sc1 lds
    buffer_load_dwordx4 v235, s[20:23], s67 offen offset:3072 sc1 lds
    s_add_u32 m0, s65, 4096
    s_add_u32 s67, s67, 4096
    buffer_load_dwordx4 v235, s[20:23], s67 offen offset:0 sc1 lds
    buffer_load_dwordx4 v235, s[20:23], s67 offen offset:1024 sc1 lds
    buffer_load_dwordx4 v235, s[20:23], s67 offen offset:2048 sc1 lds
    buffer_load_dwordx4 v235, s[20:23], s67 offen offset:3072 sc1 lds
    s_add_u32 s68, s72, 24
    s_cmp_ge_u32 s68, 28
    s_cselect_b32 s67, 28, 0
    s_sub_u32 s68, s68, s67
    s_lshl_b32 s67, s68, 17
    s_add_u32 s67, s67, s71
    s_add_u32 m0, s65, 81920
    s_nop 0
    buffer_load_dwordx4 v220, s[16:19], s67 offen offset:0 lds
    buffer_load_dwordx4 v221, s[16:19], s67 offen offset:1024 lds
    buffer_load_dwordx4 v222, s[16:19], s67 offen offset:2048 lds
    buffer_load_dwordx4 v223, s[16:19], s67 offen offset:3072 lds
    s_add_u32 m0, s65, 86016
    s_add_u32 s67, s67, 32768
    buffer_load_dwordx4 v220, s[16:19], s67 offen offset:0 lds
    buffer_load_dwordx4 v221, s[16:19], s67 offen offset:1024 lds
    buffer_load_dwordx4 v222, s[16:19], s67 offen offset:2048 lds
    buffer_load_dwordx4 v223, s[16:19], s67 offen offset:3072 lds
    s_waitcnt vmcnt(32)
    s_barrier
    s_add_u32 s68, s72, 26
    s_cmp_ge_u32 s68, 28
    s_cselect_b32 s67, 28, 0
    s_sub_u32 s68, s68, s67
    s_lshl_b32 s67, s68, 14
    s_add_u32 s67, s67, s62
    s_add_u32 m0, s65, 16384
    s_nop 0
    buffer_load_dwordx4 v235, s[20:23], s67 offen offset:0 sc1 lds
    buffer_load_dwordx4 v235, s[20:23], s67 offen offset:1024 sc1 lds
    buffer_load_dwordx4 v235, s[20:23], s67 offen offset:2048 sc1 lds
    buffer_load_dwordx4 v235, s[20:23], s67 offen offset:3072 sc1 lds
    s_add_u32 m0, s65, 20480
    s_add_u32 s67, s67, 4096
    buffer_load_dwordx4 v235, s[20:23], s67 offen offset:0 sc1 lds
    buffer_load_dwordx4 v235, s[20:23], s67 offen offset:1024 sc1 lds
    buffer_load_dwordx4 v235, s[20:23], s67 offen offset:2048 sc1 lds
    buffer_load_dwordx4 v235, s[20:23], s67 offen offset:3072 sc1 lds
    s_add_u32 s68, s72, 25
    s_cmp_ge_u32 s68, 28
    s_cselect_b32 s67, 28, 0
    s_sub_u32 s68, s68, s67
    s_lshl_b32 s67, s68, 17
    s_add_u32 s67, s67, s71
    s_add_u32 m0, s65, 98304
    s_nop 0
    buffer_load_dwordx4 v220, s[16:19], s67 offen offset:0 lds
    buffer_load_dwordx4 v221, s[16:19], s67 offen offset:1024 lds
    buffer_load_dwordx4 v222, s[16:19], s67 offen offset:2048 lds
    buffer_load_dwordx4 v223, s[16:19], s67 offen offset:3072 lds
    s_add_u32 m0, s65, 102400
    s_add_u32 s67, s67, 32768
    buffer_load_dwordx4 v220, s[16:19], s67 offen offset:0 lds
    buffer_load_dwordx4 v221, s[16:19], s67 offen offset:1024 lds
    buffer_load_dwordx4 v222, s[16:19], s67 offen offset:2048 lds
    buffer_load_dwordx4 v223, s[16:19], s67 offen offset:3072 lds
    s_waitcnt vmcnt(32)
    s_barrier
    s_add_u32 s68, s72, 27
    s_cmp_ge_u32 s68, 28
    s_cselect_b32 s67, 28, 0
    s_sub_u32 s68, s68, s67
    s_lshl_b32 s67, s68, 14
    s_add_u32 s67, s67, s62
    s_add_u32 m0, s65, 32768
    s_nop 0
    buffer_load_dwordx4 v235, s[20:23], s67 offen offset:0 sc1 lds
    buffer_load_dwordx4 v235, s[20:23], s67 offen offset:1024 sc1 lds
    buffer_load_dwordx4 v235, s[20:23], s67 offen offset:2048 sc1 lds
    buffer_load_dwordx4 v235, s[20:23], s67 offen offset:3072 sc1 lds
    s_add_u32 m0, s65, 36864
    s_add_u32 s67, s67, 4096
    buffer_load_dwordx4 v235, s[20:23], s67 offen offset:0 sc1 lds
    buffer_load_dwordx4 v235, s[20:23], s67 offen offset:1024 sc1 lds
    buffer_load_dwordx4 v235, s[20:23], s67 offen offset:2048 sc1 lds
    buffer_load_dwordx4 v235, s[20:23], s67 offen offset:3072 sc1 lds
    s_add_u32 s68, s72, 26
    s_cmp_ge_u32 s68, 28
    s_cselect_b32 s67, 28, 0
    s_sub_u32 s68, s68, s67
    s_lshl_b32 s67, s68, 17
    s_add_u32 s67, s67, s71
    s_add_u32 m0, s65, 114688
    s_nop 0
    buffer_load_dwordx4 v220, s[16:19], s67 offen offset:0 lds
    buffer_load_dwordx4 v221, s[16:19], s67 offen offset:1024 lds
    buffer_load_dwordx4 v222, s[16:19], s67 offen offset:2048 lds
    buffer_load_dwordx4 v223, s[16:19], s67 offen offset:3072 lds
    s_add_u32 m0, s65, 118784
    s_add_u32 s67, s67, 32768
    buffer_load_dwordx4 v220, s[16:19], s67 offen offset:0 lds
    buffer_load_dwordx4 v221, s[16:19], s67 offen offset:1024 lds
    buffer_load_dwordx4 v222, s[16:19], s67 offen offset:2048 lds
    buffer_load_dwordx4 v223, s[16:19], s67 offen offset:3072 lds
    s_waitcnt vmcnt(32)
    s_barrier
    s_add_u32 s68, s72, 27
    s_cmp_ge_u32 s68, 28
    s_cselect_b32 s67, 28, 0
    s_sub_u32 s68, s68, s67
    s_lshl_b32 s67, s68, 17
    s_add_u32 s67, s67, s71
    s_add_u32 m0, s65, 131072
    s_nop 0
    buffer_load_dwordx4 v220, s[16:19], s67 offen offset:0 lds
    buffer_load_dwordx4 v221, s[16:19], s67 offen offset:1024 lds
    buffer_load_dwordx4 v222, s[16:19], s67 offen offset:2048 lds
    buffer_load_dwordx4 v223, s[16:19], s67 offen offset:3072 lds
    s_add_u32 m0, s65, 135168
    s_add_u32 s67, s67, 32768
    buffer_load_dwordx4 v220, s[16:19], s67 offen offset:0 lds
    buffer_load_dwordx4 v221, s[16:19], s67 offen offset:1024 lds
    buffer_load_dwordx4 v222, s[16:19], s67 offen offset:2048 lds
    buffer_load_dwordx4 v223, s[16:19], s67 offen offset:3072 lds
    s_waitcnt vmcnt(24)
    s_barrier
    s_waitcnt vmcnt(8)
    s_barrier
    s_waitcnt vmcnt(0)
    s_barrier
    s_barrier
    s_barrier
    s_endpgm
gated_mix__spectral_fnet__dense_activation_squared_relu__prompt_kernel_I2:
    s_waitcnt lgkmcnt(0)
    v_add_u32 v245, 147456, v235
    s_barrier
    s_lshl_b32 s60, s5, 1
    s_lshl_b32 s60, s60, 12
    s_add_u32 s60, s60, 20971520
    ds_read_b128 v[208:211], v245 offset:0
    s_waitcnt lgkmcnt(0)
    buffer_store_dwordx4 v[208:211], v235, s[20:23], s60 offen offset:0 sc1
    s_lshl_b32 s60, s5, 1
    s_lshl_b32 s60, s60, 12
    s_add_u32 s60, s60, 20971520
    ds_read_b128 v[212:215], v245 offset:1024
    s_waitcnt lgkmcnt(0)
    buffer_store_dwordx4 v[212:215], v235, s[20:23], s60 offen offset:1024 sc1
    s_lshl_b32 s60, s5, 1
    s_lshl_b32 s60, s60, 12
    s_add_u32 s60, s60, 20971520
    ds_read_b128 v[208:211], v245 offset:2048
    s_waitcnt lgkmcnt(0)
    buffer_store_dwordx4 v[208:211], v235, s[20:23], s60 offen offset:2048 sc1
    s_lshl_b32 s60, s5, 1
    s_lshl_b32 s60, s60, 12
    s_add_u32 s60, s60, 20971520
    ds_read_b128 v[212:215], v245 offset:3072
    s_waitcnt lgkmcnt(0)
    buffer_store_dwordx4 v[212:215], v235, s[20:23], s60 offen offset:3072 sc1
    s_barrier
    s_lshl_b32 s60, s5, 1
    s_add_u32 s60, s60, 1
    s_lshl_b32 s60, s60, 12
    s_add_u32 s60, s60, 20971520
    ds_read_b128 v[208:211], v245 offset:4096
    s_waitcnt lgkmcnt(0)
    buffer_store_dwordx4 v[208:211], v235, s[20:23], s60 offen offset:0 sc1
    s_lshl_b32 s60, s5, 1
    s_add_u32 s60, s60, 1
    s_lshl_b32 s60, s60, 12
    s_add_u32 s60, s60, 20971520
    ds_read_b128 v[212:215], v245 offset:5120
    s_waitcnt lgkmcnt(0)
    buffer_store_dwordx4 v[212:215], v235, s[20:23], s60 offen offset:1024 sc1
    s_lshl_b32 s60, s5, 1
    s_add_u32 s60, s60, 1
    s_lshl_b32 s60, s60, 12
    s_add_u32 s60, s60, 20971520
    ds_read_b128 v[208:211], v245 offset:6144
    s_waitcnt lgkmcnt(0)
    buffer_store_dwordx4 v[208:211], v235, s[20:23], s60 offen offset:2048 sc1
    s_lshl_b32 s60, s5, 1
    s_add_u32 s60, s60, 1
    s_lshl_b32 s60, s60, 12
    s_add_u32 s60, s60, 20971520
    ds_read_b128 v[212:215], v245 offset:7168
    s_waitcnt lgkmcnt(0)
    buffer_store_dwordx4 v[212:215], v235, s[20:23], s60 offen offset:3072 sc1
    s_barrier
    s_lshl_b32 s60, s5, 1
    s_sub_u32 s61, 1024, s60
    s_cmp_eq_u32 s60, 0
    s_cselect_b32 s60, 512, s61
    s_lshl_b32 s60, s60, 12
    s_add_u32 s60, s60, 20971520
    ds_read_b128 v[208:211], v245 offset:8192
    s_waitcnt lgkmcnt(0)
    buffer_store_dwordx4 v[208:211], v235, s[20:23], s60 offen offset:0 sc1
    s_lshl_b32 s60, s5, 1
    s_sub_u32 s61, 1024, s60
    s_cmp_eq_u32 s60, 0
    s_cselect_b32 s60, 512, s61
    s_lshl_b32 s60, s60, 12
    s_add_u32 s60, s60, 20971520
    ds_read_b128 v[212:215], v245 offset:9216
    s_waitcnt lgkmcnt(0)
    buffer_store_dwordx4 v[212:215], v235, s[20:23], s60 offen offset:1024 sc1
    s_lshl_b32 s60, s5, 1
    s_sub_u32 s61, 1024, s60
    s_cmp_eq_u32 s60, 0
    s_cselect_b32 s60, 512, s61
    s_lshl_b32 s60, s60, 12
    s_add_u32 s60, s60, 20971520
    ds_read_b128 v[208:211], v245 offset:10240
    s_waitcnt lgkmcnt(0)
    buffer_store_dwordx4 v[208:211], v235, s[20:23], s60 offen offset:2048 sc1
    s_lshl_b32 s60, s5, 1
    s_sub_u32 s61, 1024, s60
    s_cmp_eq_u32 s60, 0
    s_cselect_b32 s60, 512, s61
    s_lshl_b32 s60, s60, 12
    s_add_u32 s60, s60, 20971520
    ds_read_b128 v[212:215], v245 offset:11264
    s_waitcnt lgkmcnt(0)
    buffer_store_dwordx4 v[212:215], v235, s[20:23], s60 offen offset:3072 sc1
    s_barrier
    s_lshl_b32 s60, s5, 1
    s_add_u32 s60, s60, 1
    s_sub_u32 s61, 1024, s60
    s_cmp_eq_u32 s60, 0
    s_cselect_b32 s60, 512, s61
    s_lshl_b32 s60, s60, 12
    s_add_u32 s60, s60, 20971520
    ds_read_b128 v[208:211], v245 offset:12288
    s_waitcnt lgkmcnt(0)
    buffer_store_dwordx4 v[208:211], v235, s[20:23], s60 offen offset:0 sc1
    s_lshl_b32 s60, s5, 1
    s_add_u32 s60, s60, 1
    s_sub_u32 s61, 1024, s60
    s_cmp_eq_u32 s60, 0
    s_cselect_b32 s60, 512, s61
    s_lshl_b32 s60, s60, 12
    s_add_u32 s60, s60, 20971520
    ds_read_b128 v[212:215], v245 offset:13312
    s_waitcnt lgkmcnt(0)
    buffer_store_dwordx4 v[212:215], v235, s[20:23], s60 offen offset:1024 sc1
    s_lshl_b32 s60, s5, 1
    s_add_u32 s60, s60, 1
    s_sub_u32 s61, 1024, s60
    s_cmp_eq_u32 s60, 0
    s_cselect_b32 s60, 512, s61
    s_lshl_b32 s60, s60, 12
    s_add_u32 s60, s60, 20971520
    ds_read_b128 v[208:211], v245 offset:14336
    s_waitcnt lgkmcnt(0)
    buffer_store_dwordx4 v[208:211], v235, s[20:23], s60 offen offset:2048 sc1
    s_lshl_b32 s60, s5, 1
    s_add_u32 s60, s60, 1
    s_sub_u32 s61, 1024, s60
    s_cmp_eq_u32 s60, 0
    s_cselect_b32 s60, 512, s61
    s_lshl_b32 s60, s60, 12
    s_add_u32 s60, s60, 20971520
    ds_read_b128 v[212:215], v245 offset:15360
    s_waitcnt lgkmcnt(0)
    buffer_store_dwordx4 v[212:215], v235, s[20:23], s60 offen offset:3072 sc1
    s_barrier
    s_barrier
    s_barrier
    s_barrier
    s_barrier
    s_waitcnt vmcnt(0)
    s_mov_b64 exec, 1
    v_mov_b32 v238, 1
    s_lshl_b32 s67, s6, 5
    s_add_u32 s67, s67, 16
    v_mov_b32 v239, s67
    buffer_atomic_add v238, v239, s[28:31], 0 offen
    s_mov_b64 exec, -1
    s_barrier
    s_barrier
    s_barrier
    s_barrier
    s_barrier
    s_barrier
    s_barrier
    s_barrier
    s_barrier
    s_barrier
    s_barrier
    s_barrier
    s_barrier
    s_barrier
    s_barrier
    s_barrier
    s_barrier
    s_barrier
    s_barrier
    s_waitcnt vmcnt(0)
    s_barrier
    s_barrier
    s_endpgm
gated_mix__spectral_fnet__dense_activation_squared_relu__prompt_kernel_S2:
    s_waitcnt lgkmcnt(0)
    s_barrier
    s_barrier
    s_barrier
    s_barrier
    s_barrier
    s_barrier
    s_barrier
    s_barrier
    s_barrier
    s_barrier
    s_barrier
    s_barrier
    s_barrier
    s_barrier
    s_barrier
    s_barrier
    s_barrier
    s_barrier
    s_barrier
    s_mov_b64 exec, 0xff
    v_lshlrev_b32 v239, 5, v1
    buffer_load_dword v240, v239, s[28:31], 0 offen offset:16 sc1
    s_mov_b64 exec, -1
    s_barrier
    s_barrier
    s_waitcnt vmcnt(0)
    s_mov_b64 exec, 0xff
    v_cmp_ne_u32 vcc, 32, v240
    s_nop 4
    s_cbranch_vccz gated_mix__spectral_fnet__dense_activation_squared_relu__prompt_kernel_ypoll_d
    s_mov_b32 s76, 200000
gated_mix__spectral_fnet__dense_activation_squared_relu__prompt_kernel_ypoll:
    buffer_load_dword v240, v239, s[28:31], 0 offen offset:16 sc1
    s_waitcnt vmcnt(0)
    v_cmp_ne_u32 vcc, 32, v240
    s_nop 4
    s_cbranch_vccz gated_mix__spectral_fnet__dense_activation_squared_relu__prompt_kernel_ypoll_d
    s_sub_u32 s76, s76, 1
    s_cmp_eq_u32 s76, 0
    s_cbranch_scc1 gated_mix__spectral_fnet__dense_activation_squared_relu__prompt_kernel_ypoll_d
    s_sleep 1
    s_branch gated_mix__spectral_fnet__dense_activation_squared_relu__prompt_kernel_ypoll
gated_mix__spectral_fnet__dense_activation_squared_relu__prompt_kernel_ypoll_d:
    s_mov_b64 exec, -1
    s_barrier
    v_lshrrev_b32 v3, 4, v1
    v_lshlrev_b32 v3, 12, v3
    v_and_b32 v4, 15, v1
    v_lshlrev_b32 v4, 4, v4
    v_add_u32 v3, v3, v4
    s_lshl_b32 s60, s75, 7
    s_lshl_b32 s61, s74, 5
    s_add_u32 s60, s60, s61
    s_lshl_b32 s60, s60, 12
    s_lshl_b32 s61, s56, 8
    s_add_u32 s60, s60, s61
    s_add_u32 s60, s60, 20971520
    s_mov_b32 m0, 147456
    s_add_u32 s61, s60, 0
    buffer_load_dwordx4 v3, s[20:23], s61 offen offset:0 sc1 lds
    s_add_u32 s61, s60, 15360
    buffer_load_dwordx4 v3, s[20:23], s61 offen offset:1024 sc1 lds
    s_add_u32 s61, s60, 30720
    buffer_load_dwordx4 v3, s[20:23], s61 offen offset:2048 sc1 lds
    s_add_u32 s61, s60, 46080
    buffer_load_dwordx4 v3, s[20:23], s61 offen offset:3072 sc1 lds
    s_mov_b32 m0, 151552
    s_add_u32 s61, s60, 65536
    buffer_load_dwordx4 v3, s[20:23], s61 offen offset:0 sc1 lds
    s_add_u32 s61, s60, 80896
    buffer_load_dwordx4 v3, s[20:23], s61 offen offset:1024 sc1 lds
    s_add_u32 s61, s60, 96256
    buffer_load_dwordx4 v3, s[20:23], s61 offen offset:2048 sc1 lds
    s_add_u32 s61, s60, 111616
    buffer_load_dwordx4 v3, s[20:23], s61 offen offset:3072 sc1 lds
    s_mov_b32 m0, 155648
    s_add_u32 s61, s60, 262144
    buffer_load_dwordx4 v3, s[20:23], s61 offen offset:0 sc1 lds
    s_add_u32 s61, s60, 277504
    buffer_load_dwordx4 v3, s[20:23], s61 offen offset:1024 sc1 lds
    s_add_u32 s61, s60, 292864
    buffer_load_dwordx4 v3, s[20:23], s61 offen offset:2048 sc1 lds
    s_add_u32 s61, s60, 308224
    buffer_load_dwordx4 v3, s[20:23], s61 offen offset:3072 sc1 lds
    s_mov_b32 m0, 159744
    s_add_u32 s61, s60, 327680
    buffer_load_dwordx4 v3, s[20:23], s61 offen offset:0 sc1 lds
    s_add_u32 s61, s60, 343040
    buffer_load_dwordx4 v3, s[20:23], s61 offen offset:1024 sc1 lds
    s_add_u32 s61, s60, 358400
    buffer_load_dwordx4 v3, s[20:23], s61 offen offset:2048 sc1 lds
    s_add_u32 s61, s60, 373760
    buffer_load_dwordx4 v3, s[20:23], s61 offen offset:3072 sc1 lds
    s_barrier
    s_barrier
    s_barrier
    s_barrier
    s_barrier
    s_waitcnt vmcnt(0)
    s_barrier
    s_barrier
    s_mov_b64 exec, 0x400
    s_cmp_eq_u32 s54, 0
    s_cbranch_scc0 gated_mix__spectral_fnet__dense_activation_squared_relu__prompt_kernel_fx1
    buffer_store_dword v237, v236, s[20:23], 0 offen
    s_branch gated_mix__spectral_fnet__dense_activation_squared_relu__prompt_kernel_fx2
gated_mix__spectral_fnet__dense_activation_squared_relu__prompt_kernel_fx1:
    buffer_store_dword v237, v236, s[20:23], 0 offen sc1
gated_mix__spectral_fnet__dense_activation_squared_relu__prompt_kernel_fx2:
    s_mov_b64 exec, 0x100
    s_mov_b32 s76, 200000
gated_mix__spectral_fnet__dense_activation_squared_relu__prompt_kernel_xpoll:
    buffer_load_dword v238, v236, s[20:23], 0 offen sc1
    s_waitcnt vmcnt(0)
    v_cmp_ne_u32 vcc, v238, v237
    s_nop 4
    s_cbranch_vccz gated_mix__spectral_fnet__dense_activation_squared_relu__prompt_kernel_xpoll_d
    s_sub_u32 s76, s76, 1
    s_cmp_eq_u32 s76, 0
    s_cbranch_scc1 gated_mix__spectral_fnet__dense_activation_squared_relu__prompt_kernel_xpoll_d
    s_sleep 0
    s_branch gated_mix__spectral_fnet__dense_activation_squared_relu__prompt_kernel_xpoll
gated_mix__spectral_fnet__dense_activation_squared_relu__prompt_kernel_xpoll_d:
    s_mov_b64 exec, -1
    s_barrier
gated_mix__spectral_fnet__dense_activation_squared_relu__prompt_kernel_end:
    s_endpgm
.section .rodata,"a"
.p2align 6
.amdhsa_kernel gated_mix__spectral_fnet__dense_activation_squared_relu__prompt_kernel
  .amdhsa_next_free_vgpr 256
  .amdhsa_next_free_sgpr 102
  .amdhsa_accum_offset 256
  .amdhsa_group_segment_fixed_size 0
  .amdhsa_kernarg_size 112
  .amdhsa_user_sgpr_count 2
  .amdhsa_user_sgpr_kernarg_segment_ptr 1
  .amdhsa_system_sgpr_workgroup_id_x 1
  .amdhsa_float_denorm_mode_32 3
.end_amdhsa_kernel
```
